```python
import torch

def _softmax(x, axis=-1):
    return torch.softmax(x, dim=axis)
def _gelu(x):
    return torch.nn.functional.gelu(x, approximate="tanh")
def _silu(x):
    return torch.nn.functional.silu(x)
def _sigmoid(x):
    return torch.sigmoid(x)
def _layernorm(x, axis=-1, eps=1e-5):
    m = x.mean(dim=axis, keepdim=True)
    v = x.var(dim=axis, keepdim=True, unbiased=False)
    return (x - m) / torch.sqrt(v + eps)
def _scatter_add(tgt, idx, src, axis=0):
    return tgt.clone().index_add_(axis, idx, src)
def _segment_sum(src, seg, n):
    out = torch.zeros((n,) + src.shape[1:], dtype=src.dtype)
    return out.index_add_(0, seg, src)
def _pad(x, pw):
    flat = tuple(v for pair in reversed(pw) for v in pair)
    return torch.nn.functional.pad(x, flat)

kernel_name = 'sequential_preLN__linear_attn_block__dense_activation_gelu__prompt'

def setup_inputs():

    _w = (lambda a: (lambda t: t.to(torch.bfloat16) if t.is_floating_point() else t)(torch.as_tensor(a)))
    def _A_setup():
        B, S, D = 1, 2048, 512
        return {
            "x": _w((lambda *s: torch.randn(*s, dtype=torch.bfloat16) * 0.05)(B, S, D)),
            "wqkv": _w((lambda *s: torch.randn(*s, dtype=torch.bfloat16) * 0.05)(D, 3 * D)),
            "wo": _w((lambda *s: torch.randn(*s, dtype=torch.bfloat16) * 0.05)(D, D)),
        }
    _A_in = _A_setup()

    def _B_setup():
        B, S, D, F = 1, 2048, 512, 1376
        return {
            "x": _w((lambda *s: torch.randn(*s, dtype=torch.bfloat16) * 0.05)(B, S, D)),
            "w1": _w((lambda *s: torch.randn(*s, dtype=torch.bfloat16) * 0.8)(D, F) * (D ** -0.5)),
            "b1": _w((lambda *s: torch.randn(*s, dtype=torch.bfloat16) * 12.8)(F) * 0.01),
            "w2": _w((lambda *s: torch.randn(*s, dtype=torch.bfloat16) * 0.2)(F, D) * (F ** -0.5)),
            "b2": _w((lambda *s: torch.randn(*s, dtype=torch.bfloat16) * 3.2)(D) * 0.01),
        }
    _B_in = _B_setup()

    return {
        "A_x": _A_in["x"],
        "A_wqkv": _A_in["wqkv"],
        "A_wo": _A_in["wo"],
        "B_x": _B_in["x"],
        "B_w1": _B_in["w1"],
        "B_b1": _B_in["b1"],
        "B_w2": _B_in["w2"],
        "B_b2": _B_in["b2"],
    }

def reference(A_x, A_wqkv, A_wo, B_x, B_w1, B_b1, B_w2, B_b2):
    def _A_ref(x, wqkv, wo):
        B, S, D = x.shape
        H = 32; Dh = D // H
        qkv = (lambda x, *d: x.permute(*d))((x @ wqkv).reshape(B, S, 3, H, Dh), 2, 0, 3, 1, 4)
        q, k, v = qkv[0], qkv[1], qkv[2]
        phi = lambda t: torch.where(t > 0, t + 1, torch.exp(t)) + 1e-6
        pq, pk = phi(q), phi(k)
        kv = torch.einsum("bhsd,bhse->bhde", pk, v)
        z = torch.einsum("bhsd->bhd", pk)
        num = torch.einsum("bhqd,bhde->bhqe", pq, kv)
        den = torch.einsum("bhqd,bhd->bhq", pq, z)[..., None] + 1e-6
        o = num / den
        return (lambda x, *d: x.permute(*d))(o, 0, 2, 1, 3).reshape(B, S, D) @ wo

    def _B_ref(x, w1, b1, w2, b2):
        h = torch.einsum("bsd,df->bsf", x, w1) + b1
        h = _gelu(h)
        return torch.einsum("bsf,fd->bsd", h, w2) + b2

    x = A_x
    h = x + _A_ref(_layernorm(x, axis=-1), A_wqkv, A_wo)
    h2 = h + _B_ref(_layernorm(h, axis=-1), B_w1, B_b1, B_w2, B_b2)
    return h2
```

```asm
; @launch grid=(256,1,1) block=(512,1,1) lds=163840
.amdgcn_target "amdgcn-amd-amdhsa--gfx950"
.text
.globl sequential_preLN__linear_attn_block__dense_activation_gelu__prompt_kernel
.p2align 8
.type sequential_preLN__linear_attn_block__dense_activation_gelu__prompt_kernel,@function
sequential_preLN__linear_attn_block__dense_activation_gelu__prompt_kernel:
	s_getpc_b64 s[64:65]
	s_load_dwordx2 s[8:9], s[0:1], 0
	s_lshl_b32 s51, s2, 6
	s_and_b32 s51, s51, 0x600
	v_and_b32 v2, 0x1f8, v0
	v_or_b32 v2, s51, v2
	v_min_u32 v2, (CODE_END-sequential_preLN__linear_attn_block__dense_activation_gelu__prompt_kernel-8)>>4, v2
	v_mov_b32 v3, 0
	v_lshl_add_u64 v[2:3], v[2:3], 4, s[64:65]
	global_load_dword a127, v[2:3], off
	s_load_dwordx2 s[44:45], s[0:1], 80
	s_cmpk_ge_u32 s2, 256
	s_cbranch_scc1 L_end
	v_readfirstlane_b32 s69, v0
	v_lshrrev_b32 v4, 3, v0
	v_and_b32 v5, 7, v0
	v_lshlrev_b32 v5, 4, v5
	v_lshl_add_u32 v62, v4, 10, v5
	s_lshr_b32 s48, s2, 5
	s_and_b32 s4, s2, 6
	s_lshl2_add_u32 s4, s4, s48
	s_lshl_b32 s50, s4, 16
	v_add_u32 v62, s50, v62
	s_and_b32 s7, s48, 3
	s_lshl_b32 s55, s7, 8
	s_mov_b32 s10, 2097152
	s_mov_b32 s11, 0x20000
	s_add_u32 s66, s2, s69
	s_cmp_lt_u32 s66, 20
	s_waitcnt lgkmcnt(0)
	s_cbranch_scc1 L_init
L_noinit:
	buffer_load_dwordx4 v[68:71], v62, s[8:11], s55 offen offset:0
	buffer_load_dwordx4 v[76:79], v62, s[8:11], s55 offen offset:128
	s_addk_i32 s55, 256
	s_bitset0_b32 s55, 10
	s_cmpk_ge_u32 s69, 256
	s_cbranch_scc1 L_hsetup
	buffer_load_dwordx4 v[84:87], v62, s[8:11], s55 offen offset:0
	buffer_load_dwordx4 v[92:95], v62, s[8:11], s55 offen offset:128
	s_addk_i32 s55, 256
	s_bitset0_b32 s55, 10
	buffer_load_dwordx4 v[100:103], v62, s[8:11], s55 offen offset:0
	buffer_load_dwordx4 v[108:111], v62, s[8:11], s55 offen offset:128
	s_addk_i32 s55, 256
	s_bitset0_b32 s55, 10
	buffer_load_dwordx4 v[116:119], v62, s[8:11], s55 offen offset:0
	buffer_load_dwordx4 v[124:127], v62, s[8:11], s55 offen offset:128
	s_load_dwordx2 s[40:41], s[0:1], 72
	s_load_dwordx2 s[12:13], s[0:1], 8
	s_load_dwordx2 s[24:25], s[0:1], 40
	s_load_dwordx2 s[32:33], s[0:1], 56
	s_load_dwordx2 s[36:37], s[0:1], 64
	s_mov_b32 s42, 256
	s_mov_b32 s43, 0x20000
	s_mov_b32 s14, 1572864
	s_mov_b32 s15, 0x20000
	s_mov_b32 s26, 2752
	s_mov_b32 s27, 0x20000
	s_mov_b32 s34, 1024
	s_mov_b32 s35, 0x20000
	s_mov_b32 s38, 2097152
	s_mov_b32 s39, 0x20000
	v_and_b32 v2, 15, v4
	v_lshlrev_b32 v2, 4, v2
	v_xor_b32 v2, v2, v5
	v_lshl_add_u32 v60, v4, 8, v2
	v_xor_b32 v61, 128, v60
	v_mov_b32 v56, 0
	v_mov_b32 v57, 0
	s_mov_b32 s63, 0xffff0000
	s_mov_b32 s6, 0x3f803f80
	v_and_b32 v0, 63, v0
	v_lshlrev_b32 v1, 7, v0
	s_bfe_u32 s58, s2, 0x20003
	s_bfe_u32 s3, s69, 0x20006
	s_and_b32 s51, s2, 1
	s_lshl1_add_u32 s5, s58, s51
	s_and_b32 s50, s48, 1
	s_xor_b32 s58, s58, 2
	s_lshl1_add_u32 s50, s58, s50
	s_mul_i32 s49, s51, 22
	s_add_u32 s65, s49, s50
	s_lshl_b32 s65, s65, 1
	s_sub_u32 s51, 6, s51
	s_cmp_lt_u32 s50, s51
	s_cselect_b32 s64, 0, 0x40000000
	s_min_u32 s51, s51, s50
	s_add_u32 s49, s49, s51
	s_lshl1_add_u32 s49, s50, s49
	s_mov_b32 s46, 12582912
	s_mov_b32 s47, 0x20000
	s_setprio 2
	s_waitcnt lgkmcnt(0)
	s_waitcnt vmcnt(7)
	v_dot2c_f32_bf16 v56, s6, v68
	s_cmp_ge_u32 s66, 20
	s_nop 1
	s_cbranch_scc1 L_noinit2
	s_mov_b32 s59, 1
	s_atomic_add s59, s[40:41], 0
L_noinit2:
	v_dot2c_f32_bf16 v57, v68, v68
	v_dot2c_f32_bf16 v56, s6, v69
	v_dot2c_f32_bf16 v57, v69, v69
	v_dot2c_f32_bf16 v56, s6, v70
	v_dot2c_f32_bf16 v57, v70, v70
	v_dot2c_f32_bf16 v56, s6, v71
	v_dot2c_f32_bf16 v57, v71, v71
	v_lshlrev_b32 v64, 16, v68
	v_and_b32 v65, s63, v68
	v_lshlrev_b32 v66, 16, v69
	v_and_b32 v67, s63, v69
	v_lshlrev_b32 v68, 16, v70
	v_and_b32 v69, s63, v70
	v_lshlrev_b32 v70, 16, v71
	v_and_b32 v71, s63, v71
	s_waitcnt vmcnt(6)
	v_dot2c_f32_bf16 v56, s6, v76
	v_dot2c_f32_bf16 v57, v76, v76
	v_dot2c_f32_bf16 v56, s6, v77
	v_dot2c_f32_bf16 v57, v77, v77
	v_dot2c_f32_bf16 v56, s6, v78
	v_dot2c_f32_bf16 v57, v78, v78
	v_dot2c_f32_bf16 v56, s6, v79
	v_dot2c_f32_bf16 v57, v79, v79
	v_lshlrev_b32 v72, 16, v76
	v_and_b32 v73, s63, v76
	v_lshlrev_b32 v74, 16, v77
	v_and_b32 v75, s63, v77
	v_lshlrev_b32 v76, 16, v78
	v_and_b32 v77, s63, v78
	v_lshlrev_b32 v78, 16, v79
	v_and_b32 v79, s63, v79
	s_waitcnt vmcnt(5)
	v_dot2c_f32_bf16 v56, s6, v84
	v_dot2c_f32_bf16 v57, v84, v84
	v_dot2c_f32_bf16 v56, s6, v85
	v_dot2c_f32_bf16 v57, v85, v85
	v_dot2c_f32_bf16 v56, s6, v86
	v_dot2c_f32_bf16 v57, v86, v86
	v_dot2c_f32_bf16 v56, s6, v87
	v_dot2c_f32_bf16 v57, v87, v87
	v_lshlrev_b32 v80, 16, v84
	v_and_b32 v81, s63, v84
	v_lshlrev_b32 v82, 16, v85
	v_and_b32 v83, s63, v85
	v_lshlrev_b32 v84, 16, v86
	v_and_b32 v85, s63, v86
	v_lshlrev_b32 v86, 16, v87
	v_and_b32 v87, s63, v87
	s_waitcnt vmcnt(4)
	v_dot2c_f32_bf16 v56, s6, v92
	v_dot2c_f32_bf16 v57, v92, v92
	v_dot2c_f32_bf16 v56, s6, v93
	v_dot2c_f32_bf16 v57, v93, v93
	v_dot2c_f32_bf16 v56, s6, v94
	v_dot2c_f32_bf16 v57, v94, v94
	v_dot2c_f32_bf16 v56, s6, v95
	v_dot2c_f32_bf16 v57, v95, v95
	v_lshlrev_b32 v88, 16, v92
	v_and_b32 v89, s63, v92
	v_lshlrev_b32 v90, 16, v93
	v_and_b32 v91, s63, v93
	v_lshlrev_b32 v92, 16, v94
	v_and_b32 v93, s63, v94
	v_lshlrev_b32 v94, 16, v95
	v_and_b32 v95, s63, v95
	s_waitcnt vmcnt(3)
	v_dot2c_f32_bf16 v56, s6, v100
	v_dot2c_f32_bf16 v57, v100, v100
	v_dot2c_f32_bf16 v56, s6, v101
	v_dot2c_f32_bf16 v57, v101, v101
	v_dot2c_f32_bf16 v56, s6, v102
	v_dot2c_f32_bf16 v57, v102, v102
	v_dot2c_f32_bf16 v56, s6, v103
	v_dot2c_f32_bf16 v57, v103, v103
	v_lshlrev_b32 v96, 16, v100
	v_and_b32 v97, s63, v100
	v_lshlrev_b32 v98, 16, v101
	v_and_b32 v99, s63, v101
	v_lshlrev_b32 v100, 16, v102
	v_and_b32 v101, s63, v102
	v_lshlrev_b32 v102, 16, v103
	v_and_b32 v103, s63, v103
	s_waitcnt vmcnt(2)
	v_dot2c_f32_bf16 v56, s6, v108
	v_dot2c_f32_bf16 v57, v108, v108
	v_dot2c_f32_bf16 v56, s6, v109
	v_dot2c_f32_bf16 v57, v109, v109
	v_dot2c_f32_bf16 v56, s6, v110
	v_dot2c_f32_bf16 v57, v110, v110
	v_dot2c_f32_bf16 v56, s6, v111
	v_dot2c_f32_bf16 v57, v111, v111
	v_lshlrev_b32 v104, 16, v108
	v_and_b32 v105, s63, v108
	v_lshlrev_b32 v106, 16, v109
	v_and_b32 v107, s63, v109
	v_lshlrev_b32 v108, 16, v110
	v_and_b32 v109, s63, v110
	v_lshlrev_b32 v110, 16, v111
	v_and_b32 v111, s63, v111
	s_waitcnt vmcnt(1)
	v_dot2c_f32_bf16 v56, s6, v116
	v_dot2c_f32_bf16 v57, v116, v116
	v_dot2c_f32_bf16 v56, s6, v117
	v_dot2c_f32_bf16 v57, v117, v117
	v_dot2c_f32_bf16 v56, s6, v118
	v_dot2c_f32_bf16 v57, v118, v118
	v_dot2c_f32_bf16 v56, s6, v119
	v_dot2c_f32_bf16 v57, v119, v119
	v_lshlrev_b32 v112, 16, v116
	v_and_b32 v113, s63, v116
	v_lshlrev_b32 v114, 16, v117
	v_and_b32 v115, s63, v117
	v_lshlrev_b32 v116, 16, v118
	v_and_b32 v117, s63, v118
	v_lshlrev_b32 v118, 16, v119
	v_and_b32 v119, s63, v119
	s_waitcnt vmcnt(0)
	v_dot2c_f32_bf16 v56, s6, v124
	v_dot2c_f32_bf16 v57, v124, v124
	v_dot2c_f32_bf16 v56, s6, v125
	v_dot2c_f32_bf16 v57, v125, v125
	v_dot2c_f32_bf16 v56, s6, v126
	v_dot2c_f32_bf16 v57, v126, v126
	v_dot2c_f32_bf16 v56, s6, v127
	v_dot2c_f32_bf16 v57, v127, v127
	v_lshlrev_b32 v120, 16, v124
	v_and_b32 v121, s63, v124
	v_lshlrev_b32 v122, 16, v125
	v_add_f32_dpp v56, v56, v56 quad_perm:[1,0,3,2] row_mask:0xf bank_mask:0xf
	v_add_f32_dpp v57, v57, v57 quad_perm:[1,0,3,2] row_mask:0xf bank_mask:0xf
	v_and_b32 v123, s63, v125
	v_add_f32_dpp v56, v56, v56 quad_perm:[2,3,0,1] row_mask:0xf bank_mask:0xf
	v_add_f32_dpp v57, v57, v57 quad_perm:[2,3,0,1] row_mask:0xf bank_mask:0xf
	v_lshlrev_b32 v124, 16, v126
	v_add_f32_dpp v56, v56, v56 row_half_mirror row_mask:0xf bank_mask:0xf
	v_add_f32_dpp v57, v57, v57 row_half_mirror row_mask:0xf bank_mask:0xf
	v_and_b32 v125, s63, v126
	v_mul_f32 v56, 0x3b000000, v56
	v_mul_f32 v57, 0x3b000000, v57
	v_fma_f32 v57, -v56, v56, v57
	v_max_f32 v57, 0, v57
	v_add_f32 v57, 0x3727c5ac, v57
	v_rsq_f32 v58, v57
	v_lshlrev_b32 v126, 16, v127
	v_and_b32 v127, s63, v127
	v_mul_f32_e64 v59, -v56, v58
	v_pk_fma_f32 v[64:65], v[64:65], v[58:59], v[58:59] op_sel:[0,0,1] op_sel_hi:[1,0,1]
	v_pk_fma_f32 v[66:67], v[66:67], v[58:59], v[58:59] op_sel:[0,0,1] op_sel_hi:[1,0,1]
	v_pk_fma_f32 v[68:69], v[68:69], v[58:59], v[58:59] op_sel:[0,0,1] op_sel_hi:[1,0,1]
	v_pk_fma_f32 v[70:71], v[70:71], v[58:59], v[58:59] op_sel:[0,0,1] op_sel_hi:[1,0,1]
	v_cvt_pk_bf16_f32 v64, v64, v65
	v_cvt_pk_bf16_f32 v65, v66, v67
	v_cvt_pk_bf16_f32 v66, v68, v69
	v_cvt_pk_bf16_f32 v67, v70, v71
	ds_write_b128 v60, v[64:67] offset:0
	v_pk_fma_f32 v[72:73], v[72:73], v[58:59], v[58:59] op_sel:[0,0,1] op_sel_hi:[1,0,1]
	v_pk_fma_f32 v[74:75], v[74:75], v[58:59], v[58:59] op_sel:[0,0,1] op_sel_hi:[1,0,1]
	v_pk_fma_f32 v[76:77], v[76:77], v[58:59], v[58:59] op_sel:[0,0,1] op_sel_hi:[1,0,1]
	v_pk_fma_f32 v[78:79], v[78:79], v[58:59], v[58:59] op_sel:[0,0,1] op_sel_hi:[1,0,1]
	v_cvt_pk_bf16_f32 v72, v72, v73
	v_cvt_pk_bf16_f32 v73, v74, v75
	v_cvt_pk_bf16_f32 v74, v76, v77
	v_cvt_pk_bf16_f32 v75, v78, v79
	ds_write_b128 v61, v[72:75] offset:0
	v_pk_fma_f32 v[80:81], v[80:81], v[58:59], v[58:59] op_sel:[0,0,1] op_sel_hi:[1,0,1]
	v_pk_fma_f32 v[82:83], v[82:83], v[58:59], v[58:59] op_sel:[0,0,1] op_sel_hi:[1,0,1]
	v_pk_fma_f32 v[84:85], v[84:85], v[58:59], v[58:59] op_sel:[0,0,1] op_sel_hi:[1,0,1]
	v_pk_fma_f32 v[86:87], v[86:87], v[58:59], v[58:59] op_sel:[0,0,1] op_sel_hi:[1,0,1]
	v_cvt_pk_bf16_f32 v80, v80, v81
	v_cvt_pk_bf16_f32 v81, v82, v83
	v_cvt_pk_bf16_f32 v82, v84, v85
	v_cvt_pk_bf16_f32 v83, v86, v87
	ds_write_b128 v60, v[80:83] offset:16384
	v_pk_fma_f32 v[88:89], v[88:89], v[58:59], v[58:59] op_sel:[0,0,1] op_sel_hi:[1,0,1]
	v_pk_fma_f32 v[90:91], v[90:91], v[58:59], v[58:59] op_sel:[0,0,1] op_sel_hi:[1,0,1]
	v_pk_fma_f32 v[92:93], v[92:93], v[58:59], v[58:59] op_sel:[0,0,1] op_sel_hi:[1,0,1]
	v_pk_fma_f32 v[94:95], v[94:95], v[58:59], v[58:59] op_sel:[0,0,1] op_sel_hi:[1,0,1]
	v_cvt_pk_bf16_f32 v88, v88, v89
	v_cvt_pk_bf16_f32 v89, v90, v91
	v_cvt_pk_bf16_f32 v90, v92, v93
	v_cvt_pk_bf16_f32 v91, v94, v95
	ds_write_b128 v61, v[88:91] offset:16384
	v_pk_fma_f32 v[96:97], v[96:97], v[58:59], v[58:59] op_sel:[0,0,1] op_sel_hi:[1,0,1]
	v_pk_fma_f32 v[98:99], v[98:99], v[58:59], v[58:59] op_sel:[0,0,1] op_sel_hi:[1,0,1]
	v_pk_fma_f32 v[100:101], v[100:101], v[58:59], v[58:59] op_sel:[0,0,1] op_sel_hi:[1,0,1]
	v_pk_fma_f32 v[102:103], v[102:103], v[58:59], v[58:59] op_sel:[0,0,1] op_sel_hi:[1,0,1]
	v_cvt_pk_bf16_f32 v96, v96, v97
	v_cvt_pk_bf16_f32 v97, v98, v99
	v_cvt_pk_bf16_f32 v98, v100, v101
	v_cvt_pk_bf16_f32 v99, v102, v103
	ds_write_b128 v60, v[96:99] offset:32768
	v_pk_fma_f32 v[104:105], v[104:105], v[58:59], v[58:59] op_sel:[0,0,1] op_sel_hi:[1,0,1]
	v_pk_fma_f32 v[106:107], v[106:107], v[58:59], v[58:59] op_sel:[0,0,1] op_sel_hi:[1,0,1]
	v_pk_fma_f32 v[108:109], v[108:109], v[58:59], v[58:59] op_sel:[0,0,1] op_sel_hi:[1,0,1]
	v_pk_fma_f32 v[110:111], v[110:111], v[58:59], v[58:59] op_sel:[0,0,1] op_sel_hi:[1,0,1]
	v_cvt_pk_bf16_f32 v104, v104, v105
	v_cvt_pk_bf16_f32 v105, v106, v107
	v_cvt_pk_bf16_f32 v106, v108, v109
	v_cvt_pk_bf16_f32 v107, v110, v111
	ds_write_b128 v61, v[104:107] offset:32768
	v_pk_fma_f32 v[112:113], v[112:113], v[58:59], v[58:59] op_sel:[0,0,1] op_sel_hi:[1,0,1]
	v_pk_fma_f32 v[114:115], v[114:115], v[58:59], v[58:59] op_sel:[0,0,1] op_sel_hi:[1,0,1]
	v_pk_fma_f32 v[116:117], v[116:117], v[58:59], v[58:59] op_sel:[0,0,1] op_sel_hi:[1,0,1]
	v_pk_fma_f32 v[118:119], v[118:119], v[58:59], v[58:59] op_sel:[0,0,1] op_sel_hi:[1,0,1]
	v_cvt_pk_bf16_f32 v112, v112, v113
	v_cvt_pk_bf16_f32 v113, v114, v115
	v_cvt_pk_bf16_f32 v114, v116, v117
	v_cvt_pk_bf16_f32 v115, v118, v119
	ds_write_b128 v60, v[112:115] offset:49152
	v_pk_fma_f32 v[120:121], v[120:121], v[58:59], v[58:59] op_sel:[0,0,1] op_sel_hi:[1,0,1]
	v_pk_fma_f32 v[122:123], v[122:123], v[58:59], v[58:59] op_sel:[0,0,1] op_sel_hi:[1,0,1]
	v_pk_fma_f32 v[124:125], v[124:125], v[58:59], v[58:59] op_sel:[0,0,1] op_sel_hi:[1,0,1]
	v_pk_fma_f32 v[126:127], v[126:127], v[58:59], v[58:59] op_sel:[0,0,1] op_sel_hi:[1,0,1]
	v_cvt_pk_bf16_f32 v120, v120, v121
	v_cvt_pk_bf16_f32 v121, v122, v123
	v_cvt_pk_bf16_f32 v122, v124, v125
	v_cvt_pk_bf16_f32 v123, v126, v127
	ds_write_b128 v61, v[120:123] offset:49152
	v_lshrrev_b32 v2, 3, v0
	v_mul_u32_u24 v4, 3072, v2
	v_and_b32 v2, 2, v2
	v_and_b32 v3, 7, v0
	v_xor_b32 v40, v3, v2
	v_lshl_add_u32 v40, v40, 4, v4
	v_xor_b32 v41, 64, v40
	v_add_u32 v42, 47104, v40
	v_add_u32 v43, 70656, v41
	v_add_u32 v41, 23552, v41
	s_lshl_b32 s70, s5, 7
	s_mul_i32 s50, s3, 98304
	s_add_u32 s70, s70, s50
	s_lshl_b32 s71, s3, 12
	s_add_u32 s68, s7, 0
	s_and_b32 s68, s68, 3
	s_mul_i32 s58, s68, 393216
	s_add_u32 m0, s71, 114688
	s_add_u32 s58, s58, s70
	s_add_u32 s58, s58, 2048
	buffer_load_dwordx4 v40, s[12:15], s58 offen offset:0 lds
	buffer_load_dwordx4 v41, s[12:15], s58 offen offset:1024 lds
	buffer_load_dwordx4 v42, s[12:15], s58 offen offset:2048 lds
	buffer_load_dwordx4 v43, s[12:15], s58 offen offset:3072 lds
	s_setprio 0
	s_waitcnt lgkmcnt(0)
	v_lshlrev_b32 v5, 4, v0
	s_and_b32 s50, s3, 1
	s_lshl1_add_u32 s52, s4, s50
	s_lshr_b32 s53, s3, 1
	s_lshl_b32 s54, s3, 14
	s_add_u32 s54, s54, 98304
	v_and_b32 v2, 15, v0
	v_lshrrev_b32 v3, 4, v0
	v_xor_b32 v4, v3, v2
	v_lshlrev_b32 v4, 4, v4
	v_lshl_add_u32 v4, v2, 8, v4
	s_lshl_b32 s51, s50, 13
	v_add_u32 v66, s51, v4
	v_xor_b32 v67, 64, v66
	v_xor_b32 v68, 128, v66
	v_xor_b32 v69, 192, v66
	v_and_b32 v2, 31, v0
	v_lshrrev_b32 v3, 5, v0
	v_lshlrev_b32 v3, 3, v3
	v_lshl_add_u32 v3, v2, 7, v3
	v_and_b32 v4, 7, v0
	s_lshl_b32 s51, s53, 2
	v_xor_b32 v4, s51, v4
	v_lshl_add_u32 v3, v4, 4, v3
	s_lshl_b32 s51, s50, 12
	s_add_u32 s51, s51, 73728
	v_add_u32 v15, s51, v3
	v_xor_b32 v8, 16, v15
	v_xor_b32 v10, 32, v15
	v_xor_b32 v12, 48, v15
	v_bfe_u32 v2, v0, 2, 2
	v_lshrrev_b32 v3, 4, v0
	v_lshl_add_u32 v3, v3, 3, v2
	v_lshlrev_b32 v3, 7, v3
	v_and_b32 v4, 3, v0
	v_lshl_add_u32 v3, v4, 3, v3
	v_bfe_u32 v2, v0, 3, 2
	s_lshl_b32 s51, s53, 1
	v_xor_b32 v2, s51, v2
	v_lshl_add_u32 v3, v2, 5, v3
	v_add_u32 v70, 65536, v3
	v_xor_b32 v71, 32, v70
	v_add_u32 v72, 114688, v3
	v_xor_b32 v73, 32, v72
	v_bfe_u32 v4, v0, 4, 1
	v_cmp_eq_u32 vcc, 0, v4
	v_mov_b32 v74, 0x358637bd
	v_mov_b32 v50, v74
	v_mov_b32 v51, v74
	v_mov_b32 v52, v74
	v_mov_b32 v53, v74
	v_mov_b32 v54, v74
	v_mov_b32 v55, v74
	v_mov_b32 v56, v74
	v_mov_b32 v57, v74
	v_mov_b32 v58, v74
	v_mov_b32 v59, v74
	v_mov_b32 v60, v74
	v_mov_b32 v61, v74
	v_mov_b32 v62, v74
	v_mov_b32 v63, v74
	v_mov_b32 v64, v74
	v_mov_b32 v65, v74
	v_mov_b32 v76, 0x3fb8aa3b
	v_mov_b32 v77, 0xb5c1a2a0
	v_mov_b32 v78, s6
	v_mov_b32 v79, s6
	v_mov_b32 v80, s6
	v_mov_b32 v81, s6
	s_lshl2_add_u32 s51, s53, s50
	s_mul_i32 s51, s51, 1152
	s_add_u32 s51, s51, 147456
	v_and_b32 v3, 15, v0
	v_lshl_add_u32 v87, v3, 2, s51
	v_lshl_add_u32 v3, v3, 4, s51
	v_lshl_add_u32 v3, v4, 9, v3
	v_lshrrev_b32 v2, 5, v0
	v_xor_b32 v2, 1, v2
	v_lshl_add_u32 v86, v2, 8, v3
	v_lshlrev_b32 v89, 2, v0
	s_mul_i32 s51, s3, 2304
	s_add_u32 s51, s51, 147456
	v_add_u32 v88, s51, v89
	v_and_b32 v2, 3, v0
	v_bfe_u32 v3, v0, 3, 1
	v_lshl_add_u32 v2, v3, 2, v2
	v_lshlrev_b32 v2, 8, v2
	v_lshrrev_b32 v3, 5, v0
	v_lshl_add_u32 v3, v3, 4, v2
	v_add_u32 v2, 32, v3
	v_cndmask_b32 v14, v3, v2, vcc
	v_and_b32 v2, 4, v0
	v_lshl_add_u32 v14, v2, 11, v14
	v_bfe_u32 v2, v0, 2, 2
	v_lshrrev_b32 v3, 5, v0
	v_lshl_add_u32 v3, v3, 2, v2
	v_lshlrev_b32 v3, 7, v3
	v_and_b32 v4, 3, v0
	v_lshl_add_u32 v3, v4, 3, v3
	v_bfe_u32 v4, v0, 4, 1
	v_lshl_add_u32 v3, v4, 5, v3
	v_lshrrev_b32 v2, 1, v2
	v_xor_b32 v2, s53, v2
	v_lshl_add_u32 v16, v2, 6, v3
	v_add_u32 v16, s54, v16
	v_xor_b32 v17, 64, v16
	s_lshl2_add_u32 s55, s5, s3
	s_lshl_b32 s57, s55, 8
	s_add_u32 s57, s57, 10518528
	s_and_b32 s51, s4, 1
	s_lshl_b32 s51, s51, 13
	s_add_u32 s57, s57, s51
	s_lshl_b32 s55, s55, 10
	s_add_u32 s55, s55, 10485760
	s_lshl3_add_u32 s56, s52, s5
	s_lshl1_add_u32 s56, s56, s53
	s_lshl_b32 s56, s56, 11
	s_lshl_b32 s58, s4, 10
	s_add_u32 s58, s58, 10534912
	s_lshr_b32 s50, s5, 1
	s_lshl_b32 s50, s50, 8
	s_add_u32 s50, s50, s58
	s_add_u32 s68, s44, s50
	s_addc_u32 s69, s45, 0
	s_lshl_b32 s50, s3, 8
	s_add_u32 s50, s50, s58
	s_add_u32 s70, s44, s50
	s_addc_u32 s71, s45, 0
	s_bfe_u32 s51, s2, 196611
	s_lshl2_add_u32 s51, s51, s3
	s_lshl_b32 s51, s51, 9
	s_add_u32 s51, s51, 10535040
	s_add_u32 s8, s44, s51
	s_addc_u32 s9, s45, 0
	s_lshl_b32 s14, s3, 13
	s_lshl_b32 s12, s52, 15
	s_add_u32 s12, s12, s14
	s_xor_b32 s13, s12, 0x8000
	s_add_u32 s14, s14, 10485760
	s_lshl_b32 s51, s3, 11
	s_add_u32 s51, s51, 10518528
	v_add_u32 v14, s51, v14
	s_mov_b32 s66, 1
	s_mov_b32 s7, s4
	s_waitcnt vmcnt(0)
	s_barrier
	ds_read_b128 a[0:3], v66 offset:0
	ds_read_b64_tr_b16 v[90:91], v70 offset:0
	ds_read_b64_tr_b16 v[92:93], v70 offset:512
	ds_read_b128 a[4:7], v66 offset:4096
	ds_read_b64_tr_b16 v[94:95], v72 offset:0
	ds_read_b64_tr_b16 v[96:97], v72 offset:512
	ds_read_b64_tr_b16 v[98:99], v71 offset:0
	ds_read_b64_tr_b16 v[100:101], v71 offset:512
	ds_read_b64_tr_b16 v[102:103], v73 offset:0
	ds_read_b64_tr_b16 v[104:105], v73 offset:512
	s_waitcnt lgkmcnt(4)
	v_mfma_f32_16x16x32_bf16 v[18:21], a[0:3], v[90:93], v[50:53]
	ds_read_b128 a[8:11], v67 offset:0
	v_mfma_f32_16x16x32_bf16 v[22:25], a[4:7], v[90:93], v[50:53]
	ds_read_b64_tr_b16 v[106:107], v70 offset:4096
	ds_read_b64_tr_b16 v[108:109], v70 offset:4608
	v_mfma_f32_16x16x32_bf16 v[34:37], a[0:3], v[94:97], 0
	ds_read_b128 a[12:15], v67 offset:4096
	ds_read_b64_tr_b16 v[110:111], v72 offset:4096
	v_mfma_f32_16x16x32_bf16 v[38:41], a[4:7], v[94:97], 0
	ds_read_b64_tr_b16 v[112:113], v72 offset:4608
	s_waitcnt lgkmcnt(6)
	v_mfma_f32_16x16x32_bf16 v[26:29], a[0:3], v[98:101], v[50:53]
	ds_read_b64_tr_b16 v[114:115], v71 offset:4096
	v_mfma_f32_16x16x32_bf16 v[30:33], a[4:7], v[98:101], v[50:53]
	ds_read_b64_tr_b16 v[116:117], v71 offset:4608
	ds_read_b64_tr_b16 v[118:119], v73 offset:4096
	v_mfma_f32_16x16x32_bf16 v[42:45], a[0:3], v[102:105], 0
	ds_read_b128 a[16:19], v68 offset:0
	ds_read_b64_tr_b16 v[120:121], v73 offset:4608
	v_mfma_f32_16x16x32_bf16 v[46:49], a[4:7], v[102:105], 0
	ds_read_b64_tr_b16 v[122:123], v70 offset:8192
	s_waitcnt lgkmcnt(6)
	v_mfma_f32_16x16x32_bf16 v[18:21], a[8:11], v[106:109], v[18:21]
	ds_read_b128 a[20:23], v68 offset:4096
	v_mfma_f32_16x16x32_bf16 v[22:25], a[12:15], v[106:109], v[22:25]
	ds_read_b64_tr_b16 v[124:125], v70 offset:8704
	ds_read_b64_tr_b16 v[90:91], v72 offset:8192
	v_mfma_f32_16x16x32_bf16 v[34:37], a[8:11], v[110:113], v[34:37]
	ds_read_b64_tr_b16 v[92:93], v72 offset:8704
	ds_read_b64_tr_b16 v[94:95], v71 offset:8192
	v_mfma_f32_16x16x32_bf16 v[38:41], a[12:15], v[110:113], v[38:41]
	ds_read_b64_tr_b16 v[96:97], v71 offset:8704
	s_waitcnt lgkmcnt(7)
	v_mfma_f32_16x16x32_bf16 v[26:29], a[8:11], v[114:117], v[26:29]
	ds_read_b64_tr_b16 v[98:99], v73 offset:8192
	v_mfma_f32_16x16x32_bf16 v[30:33], a[12:15], v[114:117], v[30:33]
	ds_read_b64_tr_b16 v[100:101], v73 offset:8704
	v_mfma_f32_16x16x32_bf16 v[42:45], a[8:11], v[118:121], v[42:45]
	ds_read_b128 a[24:27], v69 offset:0
	ds_read_b64_tr_b16 v[102:103], v70 offset:12288
	v_mfma_f32_16x16x32_bf16 v[46:49], a[12:15], v[118:121], v[46:49]
	ds_read_b64_tr_b16 v[104:105], v70 offset:12800
	s_waitcnt lgkmcnt(7)
	v_mfma_f32_16x16x32_bf16 v[18:21], a[16:19], v[122:125], v[18:21]
	ds_read_b128 a[28:31], v69 offset:4096
	v_mfma_f32_16x16x32_bf16 v[22:25], a[20:23], v[122:125], v[22:25]
	ds_read_b64_tr_b16 v[106:107], v72 offset:12288
	ds_read_b64_tr_b16 v[108:109], v72 offset:12800
	v_mfma_f32_16x16x32_bf16 v[34:37], a[16:19], v[90:93], v[34:37]
	ds_read_b64_tr_b16 v[110:111], v71 offset:12288
	ds_read_b64_tr_b16 v[112:113], v71 offset:12800
	v_mfma_f32_16x16x32_bf16 v[38:41], a[20:23], v[90:93], v[38:41]
	s_waitcnt lgkmcnt(8)
	v_mfma_f32_16x16x32_bf16 v[26:29], a[16:19], v[94:97], v[26:29]
	ds_read_b64_tr_b16 v[114:115], v73 offset:12288
	v_mfma_f32_16x16x32_bf16 v[30:33], a[20:23], v[94:97], v[30:33]
	ds_read_b64_tr_b16 v[116:117], v73 offset:12800
	v_mfma_f32_16x16x32_bf16 v[42:45], a[16:19], v[98:101], v[42:45]
	ds_read_b128 a[32:35], v66 offset:16384
	v_mfma_f32_16x16x32_bf16 v[46:49], a[20:23], v[98:101], v[46:49]
	s_waitcnt lgkmcnt(5)
	v_mfma_f32_16x16x32_bf16 v[18:21], a[24:27], v[102:105], v[18:21]
	ds_read_b128 a[36:39], v66 offset:20480
	v_mfma_f32_16x16x32_bf16 v[22:25], a[28:31], v[102:105], v[22:25]
	s_waitcnt lgkmcnt(2)
	s_barrier
	v_mfma_f32_16x16x32_bf16 v[34:37], a[24:27], v[106:109], v[34:37]
	ds_read_b64_tr_b16 v[118:119], v70 offset:16384
	ds_read_b64_tr_b16 v[120:121], v70 offset:16896
	v_mfma_f32_16x16x32_bf16 v[38:41], a[28:31], v[106:109], v[38:41]
	ds_read_b64_tr_b16 v[122:123], v72 offset:16384
	v_mfma_f32_16x16x32_bf16 v[26:29], a[24:27], v[110:113], v[26:29]
	ds_read_b64_tr_b16 v[124:125], v72 offset:16896
	v_mfma_f32_16x16x32_bf16 v[30:33], a[28:31], v[110:113], v[30:33]
	ds_read_b64_tr_b16 v[90:91], v71 offset:16384
	ds_read_b64_tr_b16 v[92:93], v71 offset:16896
	v_mfma_f32_16x16x32_bf16 v[42:45], a[24:27], v[114:117], v[42:45]
	ds_read_b128 a[40:43], v67 offset:16384
	ds_read_b64_tr_b16 v[94:95], v73 offset:16384
	v_mfma_f32_16x16x32_bf16 v[46:49], a[28:31], v[114:117], v[46:49]
	ds_read_b64_tr_b16 v[96:97], v73 offset:16896
	s_waitcnt lgkmcnt(5)
	v_mfma_f32_16x16x32_bf16 v[18:21], a[32:35], v[118:121], v[18:21]
	ds_read_b128 a[44:47], v67 offset:20480
	v_mfma_f32_16x16x32_bf16 v[22:25], a[36:39], v[118:121], v[22:25]
	ds_read_b64_tr_b16 v[98:99], v70 offset:20480
	ds_read_b64_tr_b16 v[100:101], v70 offset:20992
	v_mfma_f32_16x16x32_bf16 v[34:37], a[32:35], v[122:125], v[34:37]
	ds_read_b64_tr_b16 v[102:103], v72 offset:20480
	ds_read_b64_tr_b16 v[104:105], v72 offset:20992
	v_mfma_f32_16x16x32_bf16 v[38:41], a[36:39], v[122:125], v[38:41]
	ds_read_b64_tr_b16 v[106:107], v71 offset:20480
	s_waitcnt lgkmcnt(6)
	v_mfma_f32_16x16x32_bf16 v[26:29], a[32:35], v[90:93], v[26:29]
	ds_read_b64_tr_b16 v[108:109], v71 offset:20992
	v_mfma_f32_16x16x32_bf16 v[30:33], a[36:39], v[90:93], v[30:33]
	ds_read_b64_tr_b16 v[110:111], v73 offset:20480
	ds_read_b64_tr_b16 v[112:113], v73 offset:20992
	v_mfma_f32_16x16x32_bf16 v[42:45], a[32:35], v[94:97], v[42:45]
	ds_read_b128 a[48:51], v68 offset:16384
	ds_read_b64_tr_b16 v[114:115], v70 offset:24576
	v_mfma_f32_16x16x32_bf16 v[46:49], a[36:39], v[94:97], v[46:49]
	ds_read_b64_tr_b16 v[116:117], v70 offset:25088
	s_waitcnt lgkmcnt(7)
	v_mfma_f32_16x16x32_bf16 v[18:21], a[40:43], v[98:101], v[18:21]
	ds_read_b128 a[52:55], v68 offset:20480
	v_mfma_f32_16x16x32_bf16 v[22:25], a[44:47], v[98:101], v[22:25]
	ds_read_b64_tr_b16 v[118:119], v72 offset:24576
	ds_read_b64_tr_b16 v[120:121], v72 offset:25088
	v_mfma_f32_16x16x32_bf16 v[34:37], a[40:43], v[102:105], v[34:37]
	ds_read_b64_tr_b16 v[122:123], v71 offset:24576
	ds_read_b64_tr_b16 v[124:125], v71 offset:25088
	v_mfma_f32_16x16x32_bf16 v[38:41], a[44:47], v[102:105], v[38:41]
	s_waitcnt lgkmcnt(8)
	v_mfma_f32_16x16x32_bf16 v[26:29], a[40:43], v[106:109], v[26:29]
	ds_read_b64_tr_b16 v[90:91], v73 offset:24576
	v_mfma_f32_16x16x32_bf16 v[30:33], a[44:47], v[106:109], v[30:33]
	ds_read_b64_tr_b16 v[92:93], v73 offset:25088
	v_mfma_f32_16x16x32_bf16 v[42:45], a[40:43], v[110:113], v[42:45]
	ds_read_b128 a[56:59], v69 offset:16384
	ds_read_b64_tr_b16 v[94:95], v70 offset:28672
	v_mfma_f32_16x16x32_bf16 v[46:49], a[44:47], v[110:113], v[46:49]
	ds_read_b64_tr_b16 v[96:97], v70 offset:29184
	s_waitcnt lgkmcnt(7)
	v_mfma_f32_16x16x32_bf16 v[18:21], a[48:51], v[114:117], v[18:21]
	ds_read_b128 a[60:63], v69 offset:20480
	v_mfma_f32_16x16x32_bf16 v[22:25], a[52:55], v[114:117], v[22:25]
	ds_read_b64_tr_b16 v[98:99], v72 offset:28672
	ds_read_b64_tr_b16 v[100:101], v72 offset:29184
	v_mfma_f32_16x16x32_bf16 v[34:37], a[48:51], v[118:121], v[34:37]
	ds_read_b64_tr_b16 v[102:103], v71 offset:28672
	ds_read_b64_tr_b16 v[104:105], v71 offset:29184
	v_mfma_f32_16x16x32_bf16 v[38:41], a[52:55], v[118:121], v[38:41]
	s_waitcnt lgkmcnt(8)
	v_mfma_f32_16x16x32_bf16 v[26:29], a[48:51], v[122:125], v[26:29]
	ds_read_b64_tr_b16 v[106:107], v73 offset:28672
	v_mfma_f32_16x16x32_bf16 v[30:33], a[52:55], v[122:125], v[30:33]
	ds_read_b64_tr_b16 v[108:109], v73 offset:29184
	v_mfma_f32_16x16x32_bf16 v[42:45], a[48:51], v[90:93], v[42:45]
	ds_read_b128 a[64:67], v66 offset:32768
	v_mfma_f32_16x16x32_bf16 v[46:49], a[52:55], v[90:93], v[46:49]
	s_waitcnt lgkmcnt(5)
	v_mfma_f32_16x16x32_bf16 v[18:21], a[56:59], v[94:97], v[18:21]
	ds_read_b128 a[68:71], v66 offset:36864
	v_mfma_f32_16x16x32_bf16 v[22:25], a[60:63], v[94:97], v[22:25]
	s_waitcnt lgkmcnt(2)
	s_barrier
	v_mfma_f32_16x16x32_bf16 v[34:37], a[56:59], v[98:101], v[34:37]
	ds_read_b64_tr_b16 v[110:111], v70 offset:32768
	ds_read_b64_tr_b16 v[112:113], v70 offset:33280
	v_mfma_f32_16x16x32_bf16 v[38:41], a[60:63], v[98:101], v[38:41]
	ds_read_b64_tr_b16 v[114:115], v72 offset:32768
	v_mfma_f32_16x16x32_bf16 v[26:29], a[56:59], v[102:105], v[26:29]
	ds_read_b64_tr_b16 v[116:117], v72 offset:33280
	v_mfma_f32_16x16x32_bf16 v[30:33], a[60:63], v[102:105], v[30:33]
	ds_read_b64_tr_b16 v[118:119], v71 offset:32768
	ds_read_b64_tr_b16 v[120:121], v71 offset:33280
	v_mfma_f32_16x16x32_bf16 v[42:45], a[56:59], v[106:109], v[42:45]
	ds_read_b128 a[72:75], v67 offset:32768
	ds_read_b64_tr_b16 v[122:123], v73 offset:32768
	v_mfma_f32_16x16x32_bf16 v[46:49], a[60:63], v[106:109], v[46:49]
	ds_read_b64_tr_b16 v[124:125], v73 offset:33280
	s_waitcnt lgkmcnt(5)
	v_mfma_f32_16x16x32_bf16 v[18:21], a[64:67], v[110:113], v[18:21]
	ds_read_b128 a[76:79], v67 offset:36864
	v_mfma_f32_16x16x32_bf16 v[22:25], a[68:71], v[110:113], v[22:25]
	ds_read_b64_tr_b16 v[90:91], v70 offset:36864
	ds_read_b64_tr_b16 v[92:93], v70 offset:37376
	v_mfma_f32_16x16x32_bf16 v[34:37], a[64:67], v[114:117], v[34:37]
	ds_read_b64_tr_b16 v[94:95], v72 offset:36864
	ds_read_b64_tr_b16 v[96:97], v72 offset:37376
	v_mfma_f32_16x16x32_bf16 v[38:41], a[68:71], v[114:117], v[38:41]
	ds_read_b64_tr_b16 v[98:99], v71 offset:36864
	s_waitcnt lgkmcnt(6)
	v_mfma_f32_16x16x32_bf16 v[26:29], a[64:67], v[118:121], v[26:29]
	ds_read_b64_tr_b16 v[100:101], v71 offset:37376
	v_mfma_f32_16x16x32_bf16 v[30:33], a[68:71], v[118:121], v[30:33]
	ds_read_b64_tr_b16 v[102:103], v73 offset:36864
	ds_read_b64_tr_b16 v[104:105], v73 offset:37376
	v_mfma_f32_16x16x32_bf16 v[42:45], a[64:67], v[122:125], v[42:45]
	ds_read_b128 a[80:83], v68 offset:32768
	ds_read_b64_tr_b16 v[106:107], v70 offset:40960
	v_mfma_f32_16x16x32_bf16 v[46:49], a[68:71], v[122:125], v[46:49]
	ds_read_b64_tr_b16 v[108:109], v70 offset:41472
	s_waitcnt lgkmcnt(7)
	v_mfma_f32_16x16x32_bf16 v[18:21], a[72:75], v[90:93], v[18:21]
	ds_read_b128 a[84:87], v68 offset:36864
	v_mfma_f32_16x16x32_bf16 v[22:25], a[76:79], v[90:93], v[22:25]
	ds_read_b64_tr_b16 v[110:111], v72 offset:40960
	ds_read_b64_tr_b16 v[112:113], v72 offset:41472
	v_mfma_f32_16x16x32_bf16 v[34:37], a[72:75], v[94:97], v[34:37]
	ds_read_b64_tr_b16 v[114:115], v71 offset:40960
	ds_read_b64_tr_b16 v[116:117], v71 offset:41472
	v_mfma_f32_16x16x32_bf16 v[38:41], a[76:79], v[94:97], v[38:41]
	s_waitcnt lgkmcnt(8)
	v_mfma_f32_16x16x32_bf16 v[26:29], a[72:75], v[98:101], v[26:29]
	ds_read_b64_tr_b16 v[118:119], v73 offset:40960
	v_mfma_f32_16x16x32_bf16 v[30:33], a[76:79], v[98:101], v[30:33]
	ds_read_b64_tr_b16 v[120:121], v73 offset:41472
	v_mfma_f32_16x16x32_bf16 v[42:45], a[72:75], v[102:105], v[42:45]
	ds_read_b128 a[88:91], v69 offset:32768
	ds_read_b64_tr_b16 v[122:123], v70 offset:45056
	v_mfma_f32_16x16x32_bf16 v[46:49], a[76:79], v[102:105], v[46:49]
	ds_read_b64_tr_b16 v[124:125], v70 offset:45568
	s_waitcnt lgkmcnt(7)
	v_mfma_f32_16x16x32_bf16 v[18:21], a[80:83], v[106:109], v[18:21]
	ds_read_b128 a[92:95], v69 offset:36864
	v_mfma_f32_16x16x32_bf16 v[22:25], a[84:87], v[106:109], v[22:25]
	ds_read_b64_tr_b16 v[90:91], v72 offset:45056
	ds_read_b64_tr_b16 v[92:93], v72 offset:45568
	v_mfma_f32_16x16x32_bf16 v[34:37], a[80:83], v[110:113], v[34:37]
	ds_read_b64_tr_b16 v[94:95], v71 offset:45056
	ds_read_b64_tr_b16 v[96:97], v71 offset:45568
	v_mfma_f32_16x16x32_bf16 v[38:41], a[84:87], v[110:113], v[38:41]
	s_waitcnt lgkmcnt(8)
	v_mfma_f32_16x16x32_bf16 v[26:29], a[80:83], v[114:117], v[26:29]
	ds_read_b64_tr_b16 v[98:99], v73 offset:45056
	v_mfma_f32_16x16x32_bf16 v[30:33], a[84:87], v[114:117], v[30:33]
	ds_read_b64_tr_b16 v[100:101], v73 offset:45568
	v_mfma_f32_16x16x32_bf16 v[42:45], a[80:83], v[118:121], v[42:45]
	ds_read_b128 a[96:99], v66 offset:49152
	v_mfma_f32_16x16x32_bf16 v[46:49], a[84:87], v[118:121], v[46:49]
	s_waitcnt lgkmcnt(5)
	v_mfma_f32_16x16x32_bf16 v[18:21], a[88:91], v[122:125], v[18:21]
	ds_read_b128 a[100:103], v66 offset:53248
	v_mfma_f32_16x16x32_bf16 v[22:25], a[92:95], v[122:125], v[22:25]
	s_waitcnt lgkmcnt(2)
	s_barrier
	v_mfma_f32_16x16x32_bf16 v[34:37], a[88:91], v[90:93], v[34:37]
	ds_read_b64_tr_b16 v[102:103], v70 offset:0
	ds_read_b64_tr_b16 v[104:105], v70 offset:512
	v_mfma_f32_16x16x32_bf16 v[38:41], a[92:95], v[90:93], v[38:41]
	ds_read_b64_tr_b16 v[106:107], v72 offset:0
	v_mfma_f32_16x16x32_bf16 v[26:29], a[88:91], v[94:97], v[26:29]
	ds_read_b64_tr_b16 v[108:109], v72 offset:512
	v_mfma_f32_16x16x32_bf16 v[30:33], a[92:95], v[94:97], v[30:33]
	ds_read_b64_tr_b16 v[110:111], v71 offset:0
	ds_read_b64_tr_b16 v[112:113], v71 offset:512
	v_mfma_f32_16x16x32_bf16 v[42:45], a[88:91], v[98:101], v[42:45]
	ds_read_b128 a[104:107], v67 offset:49152
	ds_read_b64_tr_b16 v[114:115], v73 offset:0
	v_mfma_f32_16x16x32_bf16 v[46:49], a[92:95], v[98:101], v[46:49]
	ds_read_b64_tr_b16 v[116:117], v73 offset:512
	s_waitcnt lgkmcnt(5)
	v_mfma_f32_16x16x32_bf16 v[18:21], a[96:99], v[102:105], v[18:21]
	ds_read_b128 a[108:111], v67 offset:53248
	v_mfma_f32_16x16x32_bf16 v[22:25], a[100:103], v[102:105], v[22:25]
	ds_read_b64_tr_b16 v[118:119], v70 offset:4096
	ds_read_b64_tr_b16 v[120:121], v70 offset:4608
	v_mfma_f32_16x16x32_bf16 v[34:37], a[96:99], v[106:109], v[34:37]
	ds_read_b64_tr_b16 v[122:123], v72 offset:4096
	ds_read_b64_tr_b16 v[124:125], v72 offset:4608
	v_mfma_f32_16x16x32_bf16 v[38:41], a[100:103], v[106:109], v[38:41]
	ds_read_b64_tr_b16 v[90:91], v71 offset:4096
	s_waitcnt lgkmcnt(6)
	v_mfma_f32_16x16x32_bf16 v[26:29], a[96:99], v[110:113], v[26:29]
	ds_read_b64_tr_b16 v[92:93], v71 offset:4608
	v_mfma_f32_16x16x32_bf16 v[30:33], a[100:103], v[110:113], v[30:33]
	ds_read_b64_tr_b16 v[94:95], v73 offset:4096
	ds_read_b64_tr_b16 v[96:97], v73 offset:4608
	v_mfma_f32_16x16x32_bf16 v[42:45], a[96:99], v[114:117], v[42:45]
	ds_read_b128 a[112:115], v68 offset:49152
	ds_read_b64_tr_b16 v[98:99], v70 offset:8192
	v_mfma_f32_16x16x32_bf16 v[46:49], a[100:103], v[114:117], v[46:49]
	ds_read_b64_tr_b16 v[100:101], v70 offset:8704
	s_waitcnt lgkmcnt(7)
	v_mfma_f32_16x16x32_bf16 v[18:21], a[104:107], v[118:121], v[18:21]
	ds_read_b128 a[116:119], v68 offset:53248
	v_mfma_f32_16x16x32_bf16 v[22:25], a[108:111], v[118:121], v[22:25]
	ds_read_b64_tr_b16 v[102:103], v72 offset:8192
	ds_read_b64_tr_b16 v[104:105], v72 offset:8704
	v_mfma_f32_16x16x32_bf16 v[34:37], a[104:107], v[122:125], v[34:37]
	ds_read_b64_tr_b16 v[106:107], v71 offset:8192
	ds_read_b64_tr_b16 v[108:109], v71 offset:8704
	v_mfma_f32_16x16x32_bf16 v[38:41], a[108:111], v[122:125], v[38:41]
	s_waitcnt lgkmcnt(8)
	v_mfma_f32_16x16x32_bf16 v[26:29], a[104:107], v[90:93], v[26:29]
	ds_read_b64_tr_b16 v[110:111], v73 offset:8192
	v_mfma_f32_16x16x32_bf16 v[30:33], a[108:111], v[90:93], v[30:33]
	ds_read_b64_tr_b16 v[112:113], v73 offset:8704
	v_mfma_f32_16x16x32_bf16 v[42:45], a[104:107], v[94:97], v[42:45]
	ds_read_b128 a[120:123], v69 offset:49152
	ds_read_b64_tr_b16 v[114:115], v70 offset:12288
	v_mfma_f32_16x16x32_bf16 v[46:49], a[108:111], v[94:97], v[46:49]
	ds_read_b64_tr_b16 v[116:117], v70 offset:12800
	s_waitcnt lgkmcnt(7)
	v_mfma_f32_16x16x32_bf16 v[18:21], a[112:115], v[98:101], v[18:21]
	ds_read_b128 a[124:127], v69 offset:53248
	v_mfma_f32_16x16x32_bf16 v[22:25], a[116:119], v[98:101], v[22:25]
	ds_read_b64_tr_b16 v[118:119], v72 offset:12288
	ds_read_b64_tr_b16 v[120:121], v72 offset:12800
	v_mfma_f32_16x16x32_bf16 v[34:37], a[112:115], v[102:105], v[34:37]
	ds_read_b64_tr_b16 v[122:123], v71 offset:12288
	ds_read_b64_tr_b16 v[124:125], v71 offset:12800
	v_mfma_f32_16x16x32_bf16 v[38:41], a[116:119], v[102:105], v[38:41]
	s_waitcnt lgkmcnt(8)
	v_mfma_f32_16x16x32_bf16 v[26:29], a[112:115], v[106:109], v[26:29]
	ds_read_b64_tr_b16 v[90:91], v73 offset:12288
	v_mfma_f32_16x16x32_bf16 v[30:33], a[116:119], v[106:109], v[30:33]
	ds_read_b64_tr_b16 v[92:93], v73 offset:12800
	v_mfma_f32_16x16x32_bf16 v[42:45], a[112:115], v[110:113], v[42:45]
	v_mfma_f32_16x16x32_bf16 v[46:49], a[116:119], v[110:113], v[46:49]
	s_waitcnt lgkmcnt(4)
	v_mfma_f32_16x16x32_bf16 v[18:21], a[120:123], v[114:117], v[18:21]
	v_mfma_f32_16x16x32_bf16 v[22:25], a[124:127], v[114:117], v[22:25]
	v_mfma_f32_16x16x32_bf16 v[34:37], a[120:123], v[118:121], v[34:37]
	v_mfma_f32_16x16x32_bf16 v[38:41], a[124:127], v[118:121], v[38:41]
	s_waitcnt lgkmcnt(0)
	v_mfma_f32_16x16x32_bf16 v[26:29], a[120:123], v[122:125], v[26:29]
	v_mfma_f32_16x16x32_bf16 v[30:33], a[124:127], v[122:125], v[30:33]
	v_mfma_f32_16x16x32_bf16 v[42:45], a[120:123], v[90:93], v[42:45]
	v_mfma_f32_16x16x32_bf16 v[46:49], a[124:127], v[90:93], v[46:49]
	s_nop 1
	v_cvt_pk_bf16_f32 v34, v34, v35
	v_cvt_pk_bf16_f32 v35, v36, v37
	v_cvt_pk_bf16_f32 v36, v38, v39
	v_cvt_pk_bf16_f32 v37, v40, v41
	v_pk_fma_f32 v[82:83], v[18:19], v[76:77], v[76:77] op_sel:[0,0,1] op_sel_hi:[1,0,1]
	v_pk_fma_f32 v[84:85], v[20:21], v[76:77], v[76:77] op_sel:[0,0,1] op_sel_hi:[1,0,1]
	v_exp_f32 v82, v82 clamp
	v_exp_f32 v83, v83 clamp
	v_exp_f32 v84, v84 clamp
	v_exp_f32 v85, v85 clamp
	v_max_f32 v18, v18, v74
	v_max_f32 v19, v19, v74
	v_max_f32 v20, v20, v74
	v_max_f32 v21, v21, v74
	v_pk_add_f32 v[82:83], v[82:83], v[18:19]
	v_pk_add_f32 v[84:85], v[84:85], v[20:21]
	v_cvt_pk_bf16_f32 v18, v82, v83
	v_cvt_pk_bf16_f32 v19, v84, v85
	v_pk_fma_f32 v[82:83], v[22:23], v[76:77], v[76:77] op_sel:[0,0,1] op_sel_hi:[1,0,1]
	v_pk_fma_f32 v[84:85], v[24:25], v[76:77], v[76:77] op_sel:[0,0,1] op_sel_hi:[1,0,1]
	v_exp_f32 v82, v82 clamp
	v_exp_f32 v83, v83 clamp
	v_exp_f32 v84, v84 clamp
	v_exp_f32 v85, v85 clamp
	v_max_f32 v22, v22, v74
	v_max_f32 v23, v23, v74
	v_max_f32 v24, v24, v74
	v_max_f32 v25, v25, v74
	v_pk_add_f32 v[82:83], v[82:83], v[22:23]
	v_pk_add_f32 v[84:85], v[84:85], v[24:25]
	v_cvt_pk_bf16_f32 v20, v82, v83
	v_cvt_pk_bf16_f32 v21, v84, v85
	v_cvt_pk_bf16_f32 v38, v42, v43
	v_cvt_pk_bf16_f32 v39, v44, v45
	v_cvt_pk_bf16_f32 v40, v46, v47
	v_cvt_pk_bf16_f32 v41, v48, v49
	v_pk_fma_f32 v[82:83], v[26:27], v[76:77], v[76:77] op_sel:[0,0,1] op_sel_hi:[1,0,1]
	v_pk_fma_f32 v[84:85], v[28:29], v[76:77], v[76:77] op_sel:[0,0,1] op_sel_hi:[1,0,1]
	v_mfma_f32_16x16x32_bf16 v[110:113], v[18:21], v[34:37], 0
	v_mfma_f32_16x16x32_bf16 v[114:117], v[78:81], v[18:21], 0
	v_exp_f32 v82, v82 clamp
	v_exp_f32 v83, v83 clamp
	v_exp_f32 v84, v84 clamp
	v_exp_f32 v85, v85 clamp
	v_max_f32 v26, v26, v74
	v_max_f32 v27, v27, v74
	v_max_f32 v28, v28, v74
	v_max_f32 v29, v29, v74
	v_pk_add_f32 v[82:83], v[82:83], v[26:27]
	v_pk_add_f32 v[84:85], v[84:85], v[28:29]
	v_cvt_pk_bf16_f32 v22, v82, v83
	v_cvt_pk_bf16_f32 v23, v84, v85
	ds_write_b128 v86, v[110:113] offset:0
	ds_write_b32 v87, v114 offset:1024
	v_pk_fma_f32 v[82:83], v[30:31], v[76:77], v[76:77] op_sel:[0,0,1] op_sel_hi:[1,0,1]
	v_pk_fma_f32 v[84:85], v[32:33], v[76:77], v[76:77] op_sel:[0,0,1] op_sel_hi:[1,0,1]
	v_exp_f32 v82, v82 clamp
	v_exp_f32 v83, v83 clamp
	v_exp_f32 v84, v84 clamp
	v_exp_f32 v85, v85 clamp
	v_max_f32 v30, v30, v74
	v_max_f32 v31, v31, v74
	v_max_f32 v32, v32, v74
	v_max_f32 v33, v33, v74
	v_pk_add_f32 v[82:83], v[82:83], v[30:31]
	v_pk_add_f32 v[84:85], v[84:85], v[32:33]
	v_cvt_pk_bf16_f32 v24, v82, v83
	v_cvt_pk_bf16_f32 v25, v84, v85
	s_nop 1
	v_mfma_f32_16x16x32_bf16 v[118:121], v[22:25], v[38:41], 0
	v_mfma_f32_16x16x32_bf16 v[122:125], v[78:81], v[22:25], 0
	v_subrev_u32 v72, 65536, v70
	v_subrev_u32 v73, 65536, v71
	s_nop 4
	ds_write_b128 v86, v[118:121] offset:2304
	ds_write_b32 v87, v122 offset:3328
	s_waitcnt lgkmcnt(0)
	s_barrier
	ds_read_b32 v18, v88 offset:0
	ds_read_b32 v19, v88 offset:1152
	ds_read_b32 v20, v88 offset:256
	ds_read_b32 v21, v88 offset:1408
	ds_read_b32 v22, v88 offset:512
	ds_read_b32 v23, v88 offset:1664
	ds_read_b32 v24, v88 offset:768
	ds_read_b32 v25, v88 offset:1920
	ds_read_b32 v26, v88 offset:1024
	ds_read_b32 v27, v88 offset:2176
	ds_read_b64_tr_b16 v[90:91], v72 offset:0
	ds_read_b64_tr_b16 v[92:93], v72 offset:512
	s_waitcnt lgkmcnt(10)
	v_add_f32 v18, v18, v19
	buffer_atomic_add_f32 v18, v89, s[44:47], s55 offen offset:0
	ds_read_b64_tr_b16 v[94:95], v73 offset:0
	ds_read_b64_tr_b16 v[96:97], v73 offset:512
	s_waitcnt lgkmcnt(10)
	v_add_f32 v20, v20, v21
	buffer_atomic_add_f32 v20, v89, s[44:47], s55 offen offset:256
	ds_read_b64_tr_b16 v[98:99], v72 offset:4096
	ds_read_b64_tr_b16 v[100:101], v72 offset:4608
	s_waitcnt lgkmcnt(10)
	v_add_f32 v22, v22, v23
	buffer_atomic_add_f32 v22, v89, s[44:47], s55 offen offset:512
	ds_read_b64_tr_b16 v[102:103], v73 offset:4096
	ds_read_b64_tr_b16 v[104:105], v73 offset:4608
	s_waitcnt lgkmcnt(10)
	v_add_f32 v24, v24, v25
	buffer_atomic_add_f32 v24, v89, s[44:47], s55 offen offset:768
	ds_read_b64_tr_b16 v[106:107], v72 offset:8192
	ds_read_b64_tr_b16 v[108:109], v72 offset:8704
	s_waitcnt lgkmcnt(10)
	v_add_f32 v26, v26, v27
	s_mov_b64 exec, 0xffff
	buffer_atomic_add_f32 v26, v89, s[44:47], s57 offen offset:0
	s_mov_b64 exec, -1
	s_barrier
	s_setprio 2
	s_waitcnt lgkmcnt(8)
	v_mfma_f32_16x16x32_bf16 v[50:53], v[90:93], a[0:3], v[50:53]
	ds_read_b64_tr_b16 v[110:111], v73 offset:8192
	v_mfma_f32_16x16x32_bf16 v[54:57], v[90:93], a[4:7], v[54:57]
	ds_read_b64_tr_b16 v[112:113], v73 offset:8704
	s_waitcnt lgkmcnt(8)
	v_mfma_f32_16x16x32_bf16 v[58:61], v[94:97], a[0:3], v[58:61]
	ds_read_b64_tr_b16 v[114:115], v72 offset:12288
	v_mfma_f32_16x16x32_bf16 v[62:65], v[94:97], a[4:7], v[62:65]
	ds_read_b64_tr_b16 v[116:117], v72 offset:12800
	s_waitcnt lgkmcnt(6)
	v_mfma_f32_16x16x32_bf16 v[50:53], v[98:101], a[8:11], v[50:53]
	ds_read_b64_tr_b16 v[118:119], v73 offset:12288
	v_mfma_f32_16x16x32_bf16 v[54:57], v[98:101], a[12:15], v[54:57]
	ds_read_b64_tr_b16 v[120:121], v73 offset:12800
	v_mfma_f32_16x16x32_bf16 v[58:61], v[102:105], a[8:11], v[58:61]
	ds_read_b64_tr_b16 v[122:123], v72 offset:16384
	v_mfma_f32_16x16x32_bf16 v[62:65], v[102:105], a[12:15], v[62:65]
	ds_read_b64_tr_b16 v[124:125], v72 offset:16896
	s_waitcnt lgkmcnt(6)
	v_mfma_f32_16x16x32_bf16 v[50:53], v[106:109], a[16:19], v[50:53]
	ds_read_b64_tr_b16 v[90:91], v73 offset:16384
	v_mfma_f32_16x16x32_bf16 v[54:57], v[106:109], a[20:23], v[54:57]
	ds_read_b64_tr_b16 v[92:93], v73 offset:16896
	v_mfma_f32_16x16x32_bf16 v[58:61], v[110:113], a[16:19], v[58:61]
	ds_read_b64_tr_b16 v[94:95], v72 offset:20480
	v_mfma_f32_16x16x32_bf16 v[62:65], v[110:113], a[20:23], v[62:65]
	ds_read_b64_tr_b16 v[96:97], v72 offset:20992
	s_waitcnt lgkmcnt(6)
	v_mfma_f32_16x16x32_bf16 v[50:53], v[114:117], a[24:27], v[50:53]
	ds_read_b64_tr_b16 v[98:99], v73 offset:20480
	v_mfma_f32_16x16x32_bf16 v[54:57], v[114:117], a[28:31], v[54:57]
	ds_read_b64_tr_b16 v[100:101], v73 offset:20992
	v_mfma_f32_16x16x32_bf16 v[58:61], v[118:121], a[24:27], v[58:61]
	ds_read_b64_tr_b16 v[102:103], v72 offset:24576
	v_mfma_f32_16x16x32_bf16 v[62:65], v[118:121], a[28:31], v[62:65]
	ds_read_b64_tr_b16 v[104:105], v72 offset:25088
	s_waitcnt lgkmcnt(6)
	v_mfma_f32_16x16x32_bf16 v[50:53], v[122:125], a[32:35], v[50:53]
	ds_read_b64_tr_b16 v[106:107], v73 offset:24576
	v_mfma_f32_16x16x32_bf16 v[54:57], v[122:125], a[36:39], v[54:57]
	ds_read_b64_tr_b16 v[108:109], v73 offset:25088
	v_mfma_f32_16x16x32_bf16 v[58:61], v[90:93], a[32:35], v[58:61]
	ds_read_b64_tr_b16 v[110:111], v72 offset:28672
	v_mfma_f32_16x16x32_bf16 v[62:65], v[90:93], a[36:39], v[62:65]
	ds_read_b64_tr_b16 v[112:113], v72 offset:29184
	s_waitcnt lgkmcnt(6)
	v_mfma_f32_16x16x32_bf16 v[50:53], v[94:97], a[40:43], v[50:53]
	ds_read_b64_tr_b16 v[114:115], v73 offset:28672
	v_mfma_f32_16x16x32_bf16 v[54:57], v[94:97], a[44:47], v[54:57]
	ds_read_b64_tr_b16 v[116:117], v73 offset:29184
	v_mfma_f32_16x16x32_bf16 v[58:61], v[98:101], a[40:43], v[58:61]
	ds_read_b64_tr_b16 v[118:119], v70 offset:16384
	v_mfma_f32_16x16x32_bf16 v[62:65], v[98:101], a[44:47], v[62:65]
	ds_read_b64_tr_b16 v[120:121], v70 offset:16896
	s_waitcnt lgkmcnt(6)
	v_mfma_f32_16x16x32_bf16 v[50:53], v[102:105], a[48:51], v[50:53]
	ds_read_b64_tr_b16 v[122:123], v71 offset:16384
	v_mfma_f32_16x16x32_bf16 v[54:57], v[102:105], a[52:55], v[54:57]
	ds_read_b64_tr_b16 v[124:125], v71 offset:16896
	v_mfma_f32_16x16x32_bf16 v[58:61], v[106:109], a[48:51], v[58:61]
	ds_read_b64_tr_b16 v[90:91], v70 offset:20480
	v_mfma_f32_16x16x32_bf16 v[62:65], v[106:109], a[52:55], v[62:65]
	ds_read_b64_tr_b16 v[92:93], v70 offset:20992
	s_waitcnt lgkmcnt(6)
	v_mfma_f32_16x16x32_bf16 v[50:53], v[110:113], a[56:59], v[50:53]
	ds_read_b64_tr_b16 v[94:95], v71 offset:20480
	v_mfma_f32_16x16x32_bf16 v[54:57], v[110:113], a[60:63], v[54:57]
	ds_read_b64_tr_b16 v[96:97], v71 offset:20992
	v_mfma_f32_16x16x32_bf16 v[58:61], v[114:117], a[56:59], v[58:61]
	ds_read_b64_tr_b16 v[98:99], v70 offset:24576
	v_mfma_f32_16x16x32_bf16 v[62:65], v[114:117], a[60:63], v[62:65]
	ds_read_b64_tr_b16 v[100:101], v70 offset:25088
	s_waitcnt lgkmcnt(6)
	v_mfma_f32_16x16x32_bf16 v[50:53], v[118:121], a[64:67], v[50:53]
	ds_read_b64_tr_b16 v[102:103], v71 offset:24576
	v_mfma_f32_16x16x32_bf16 v[54:57], v[118:121], a[68:71], v[54:57]
	ds_read_b64_tr_b16 v[104:105], v71 offset:25088
	v_mfma_f32_16x16x32_bf16 v[58:61], v[122:125], a[64:67], v[58:61]
	ds_read_b64_tr_b16 v[106:107], v70 offset:28672
	v_mfma_f32_16x16x32_bf16 v[62:65], v[122:125], a[68:71], v[62:65]
	ds_read_b64_tr_b16 v[108:109], v70 offset:29184
	s_waitcnt lgkmcnt(6)
	v_mfma_f32_16x16x32_bf16 v[50:53], v[90:93], a[72:75], v[50:53]
	ds_read_b64_tr_b16 v[110:111], v71 offset:28672
	v_mfma_f32_16x16x32_bf16 v[54:57], v[90:93], a[76:79], v[54:57]
	ds_read_b64_tr_b16 v[112:113], v71 offset:29184
	v_mfma_f32_16x16x32_bf16 v[58:61], v[94:97], a[72:75], v[58:61]
	ds_read_b64_tr_b16 v[114:115], v72 offset:32768
	v_mfma_f32_16x16x32_bf16 v[62:65], v[94:97], a[76:79], v[62:65]
	ds_read_b64_tr_b16 v[116:117], v72 offset:33280
	s_waitcnt lgkmcnt(6)
	v_mfma_f32_16x16x32_bf16 v[50:53], v[98:101], a[80:83], v[50:53]
	ds_read_b64_tr_b16 v[118:119], v73 offset:32768
	v_mfma_f32_16x16x32_bf16 v[54:57], v[98:101], a[84:87], v[54:57]
	ds_read_b64_tr_b16 v[120:121], v73 offset:33280
	v_mfma_f32_16x16x32_bf16 v[58:61], v[102:105], a[80:83], v[58:61]
	ds_read_b64_tr_b16 v[122:123], v72 offset:36864
	v_mfma_f32_16x16x32_bf16 v[62:65], v[102:105], a[84:87], v[62:65]
	ds_read_b64_tr_b16 v[124:125], v72 offset:37376
	s_waitcnt lgkmcnt(6)
	v_mfma_f32_16x16x32_bf16 v[50:53], v[106:109], a[88:91], v[50:53]
	ds_read_b64_tr_b16 v[90:91], v73 offset:36864
	v_mfma_f32_16x16x32_bf16 v[54:57], v[106:109], a[92:95], v[54:57]
	ds_read_b64_tr_b16 v[92:93], v73 offset:37376
	v_mfma_f32_16x16x32_bf16 v[58:61], v[110:113], a[88:91], v[58:61]
	ds_read_b64_tr_b16 v[94:95], v72 offset:40960
	v_mfma_f32_16x16x32_bf16 v[62:65], v[110:113], a[92:95], v[62:65]
	ds_read_b64_tr_b16 v[96:97], v72 offset:41472
	s_waitcnt lgkmcnt(6)
	v_mfma_f32_16x16x32_bf16 v[50:53], v[114:117], a[96:99], v[50:53]
	ds_read_b64_tr_b16 v[98:99], v73 offset:40960
	v_mfma_f32_16x16x32_bf16 v[54:57], v[114:117], a[100:103], v[54:57]
	ds_read_b64_tr_b16 v[100:101], v73 offset:41472
	v_mfma_f32_16x16x32_bf16 v[58:61], v[118:121], a[96:99], v[58:61]
	ds_read_b64_tr_b16 v[102:103], v72 offset:45056
	v_mfma_f32_16x16x32_bf16 v[62:65], v[118:121], a[100:103], v[62:65]
	ds_read_b64_tr_b16 v[104:105], v72 offset:45568
	s_waitcnt lgkmcnt(6)
	v_mfma_f32_16x16x32_bf16 v[50:53], v[122:125], a[104:107], v[50:53]
	ds_read_b64_tr_b16 v[106:107], v73 offset:45056
	v_mfma_f32_16x16x32_bf16 v[54:57], v[122:125], a[108:111], v[54:57]
	ds_read_b64_tr_b16 v[108:109], v73 offset:45568
	v_mfma_f32_16x16x32_bf16 v[58:61], v[90:93], a[104:107], v[58:61]
	v_mfma_f32_16x16x32_bf16 v[62:65], v[90:93], a[108:111], v[62:65]
	s_waitcnt lgkmcnt(4)
	v_mfma_f32_16x16x32_bf16 v[50:53], v[94:97], a[112:115], v[50:53]
	v_mfma_f32_16x16x32_bf16 v[54:57], v[94:97], a[116:119], v[54:57]
	v_mfma_f32_16x16x32_bf16 v[58:61], v[98:101], a[112:115], v[58:61]
	v_mfma_f32_16x16x32_bf16 v[62:65], v[98:101], a[116:119], v[62:65]
	s_waitcnt lgkmcnt(0)
	v_mfma_f32_16x16x32_bf16 v[50:53], v[102:105], a[120:123], v[50:53]
	v_mfma_f32_16x16x32_bf16 v[54:57], v[102:105], a[124:127], v[54:57]
	v_mfma_f32_16x16x32_bf16 v[58:61], v[106:109], a[120:123], v[58:61]
	v_mfma_f32_16x16x32_bf16 v[62:65], v[106:109], a[124:127], v[62:65]
	s_nop 4
	v_pk_fma_f32 v[82:83], v[50:51], v[76:77], v[76:77] op_sel:[0,0,1] op_sel_hi:[1,0,1]
	v_pk_fma_f32 v[84:85], v[52:53], v[76:77], v[76:77] op_sel:[0,0,1] op_sel_hi:[1,0,1]
	v_exp_f32 v82, v82 clamp
	v_exp_f32 v83, v83 clamp
	v_exp_f32 v84, v84 clamp
	v_exp_f32 v85, v85 clamp
	v_max_f32 v50, v50, v74
	v_max_f32 v51, v51, v74
	v_max_f32 v52, v52, v74
	v_max_f32 v53, v53, v74
	v_pk_add_f32 v[82:83], v[82:83], v[50:51]
	v_pk_add_f32 v[84:85], v[84:85], v[52:53]
	v_cvt_pk_bf16_f32 v50, v82, v83
	v_cvt_pk_bf16_f32 v51, v84, v85
	v_pk_fma_f32 v[82:83], v[54:55], v[76:77], v[76:77] op_sel:[0,0,1] op_sel_hi:[1,0,1]
	v_pk_fma_f32 v[84:85], v[56:57], v[76:77], v[76:77] op_sel:[0,0,1] op_sel_hi:[1,0,1]
	v_exp_f32 v82, v82 clamp
	v_exp_f32 v83, v83 clamp
	v_exp_f32 v84, v84 clamp
	v_exp_f32 v85, v85 clamp
	v_max_f32 v54, v54, v74
	v_max_f32 v55, v55, v74
	v_max_f32 v56, v56, v74
	v_max_f32 v57, v57, v74
	v_pk_add_f32 v[82:83], v[82:83], v[54:55]
	v_pk_add_f32 v[84:85], v[84:85], v[56:57]
	v_cvt_pk_bf16_f32 v52, v82, v83
	v_cvt_pk_bf16_f32 v53, v84, v85
	v_pk_fma_f32 v[82:83], v[58:59], v[76:77], v[76:77] op_sel:[0,0,1] op_sel_hi:[1,0,1]
	v_pk_fma_f32 v[84:85], v[60:61], v[76:77], v[76:77] op_sel:[0,0,1] op_sel_hi:[1,0,1]
	v_permlane16_swap_b32 v50, v52
	v_permlane16_swap_b32 v51, v53
	s_nop 0
	v_permlane32_swap_b32 v50, v52
	v_permlane32_swap_b32 v51, v53
	buffer_store_dwordx4 v[50:53], v5, s[44:47], s56 offen offset:0 sc1
	v_exp_f32 v82, v82 clamp
	v_exp_f32 v83, v83 clamp
	v_exp_f32 v84, v84 clamp
	v_exp_f32 v85, v85 clamp
	v_max_f32 v58, v58, v74
	v_max_f32 v59, v59, v74
	v_max_f32 v60, v60, v74
	v_max_f32 v61, v61, v74
	v_pk_add_f32 v[82:83], v[82:83], v[58:59]
	v_pk_add_f32 v[84:85], v[84:85], v[60:61]
	v_cvt_pk_bf16_f32 v54, v82, v83
	v_cvt_pk_bf16_f32 v55, v84, v85
	v_pk_fma_f32 v[82:83], v[62:63], v[76:77], v[76:77] op_sel:[0,0,1] op_sel_hi:[1,0,1]
	v_pk_fma_f32 v[84:85], v[64:65], v[76:77], v[76:77] op_sel:[0,0,1] op_sel_hi:[1,0,1]
	v_exp_f32 v82, v82 clamp
	v_exp_f32 v83, v83 clamp
	v_exp_f32 v84, v84 clamp
	v_exp_f32 v85, v85 clamp
	v_max_f32 v62, v62, v74
	v_max_f32 v63, v63, v74
	v_max_f32 v64, v64, v74
	v_max_f32 v65, v65, v74
	v_pk_add_f32 v[82:83], v[82:83], v[62:63]
	v_pk_add_f32 v[84:85], v[84:85], v[64:65]
	v_cvt_pk_bf16_f32 v56, v82, v83
	v_cvt_pk_bf16_f32 v57, v84, v85
	s_nop 0
	v_permlane16_swap_b32 v54, v56
	v_permlane16_swap_b32 v55, v57
	s_nop 0
	v_permlane32_swap_b32 v54, v56
	v_permlane32_swap_b32 v55, v57
	buffer_store_dwordx4 v[54:57], v5, s[44:47], s56 offen offset:1024 sc1
	s_waitcnt vmcnt(2)
	s_barrier
	ds_read_b64 v[6:7], v15
	ds_read_b64 v[8:9], v8
	ds_read_b64 v[10:11], v10
	ds_read_b64 v[12:13], v12
	s_waitcnt vmcnt(0)
	s_atomic_add s66, s[68:69], 0
	v_mov_b32 v108, 0x358637bd
	v_mov_b32 v109, v108
	v_mov_b32 v110, v108
	v_mov_b32 v111, v108
	v_mov_b32 v112, v108
	v_mov_b32 v113, v108
	v_mov_b32 v114, v108
	v_mov_b32 v115, v108
	v_mov_b32 v116, 0
	v_mov_b32 v117, 0
	v_mov_b32 v118, 0
	v_mov_b32 v119, 0
	v_mov_b32 v120, 0
	v_mov_b32 v121, 0
	v_mov_b32 v122, 0
	v_mov_b32 v123, 0
	v_add_u32 v104, s54, v5
	s_lshl_b32 s50, s3, 14
	v_add_u32 v2, s50, v5
	v_xor_b32 v105, 16384, v2
	v_add_u32 v105, 98304, v105
	v_xor_b32 v106, 32768, v2
	v_add_u32 v106, 102400, v106
	v_xor_b32 v107, 49152, v2
	v_add_u32 v107, 106496, v107
	s_mov_b32 s59, 0
L_p_poll:
	s_mov_b32 s60, 0
	s_atomic_add s60, s[70:71], 0 glc
	s_mov_b32 s61, 0
	s_atomic_add s61, s[8:9], 0 glc
	s_mov_b32 s62, 0
	s_atomic_add s62, s[8:9], 256 glc
	s_add_u32 s59, s59, 1
	s_waitcnt lgkmcnt(0)
	s_lshl_b32 s60, s60, 2
	s_min_u32 s60, s60, s61
	s_min_u32 s60, s60, s62
	s_cmp_ge_u32 s60, 32
	s_cbranch_scc1 L_p_done
	s_cmp_lt_u32 s59, 262144
	s_cbranch_scc1 L_p_poll
L_p_done:
	buffer_load_dwordx4 v[100:103], v14, s[44:47], 0 offen sc1
	buffer_load_dwordx4 v[68:71], v5, s[44:47], s14 offen offset:0 sc1
	buffer_load_dwordx4 a[0:3], v5, s[44:47], s12 offen offset:0 sc1
	buffer_load_dwordx4 a[4:7], v5, s[44:47], s13 offen offset:0 sc1
	v_lshlrev_b32 v18, 16, v6
	v_and_b32 v19, 0xffff0000, v6
	v_lshlrev_b32 v20, 16, v7
	v_and_b32 v21, 0xffff0000, v7
	buffer_load_dwordx4 v[72:75], v5, s[44:47], s14 offen offset:1024 sc1
	buffer_load_dwordx4 a[8:11], v5, s[44:47], s12 offen offset:1024 sc1
	buffer_load_dwordx4 a[12:15], v5, s[44:47], s13 offen offset:1024 sc1
	v_lshlrev_b32 v22, 16, v8
	v_and_b32 v23, 0xffff0000, v8
	v_lshlrev_b32 v24, 16, v9
	v_and_b32 v25, 0xffff0000, v9
	buffer_load_dwordx4 v[76:79], v5, s[44:47], s14 offen offset:2048 sc1
	buffer_load_dwordx4 a[16:19], v5, s[44:47], s12 offen offset:2048 sc1
	buffer_load_dwordx4 a[20:23], v5, s[44:47], s13 offen offset:2048 sc1
	v_lshlrev_b32 v26, 16, v10
	v_and_b32 v27, 0xffff0000, v10
	v_lshlrev_b32 v28, 16, v11
	v_and_b32 v29, 0xffff0000, v11
	buffer_load_dwordx4 v[80:83], v5, s[44:47], s14 offen offset:3072 sc1
	buffer_load_dwordx4 a[24:27], v5, s[44:47], s12 offen offset:3072 sc1
	buffer_load_dwordx4 a[28:31], v5, s[44:47], s13 offen offset:3072 sc1
	v_lshlrev_b32 v30, 16, v12
	v_and_b32 v31, 0xffff0000, v12
	v_lshlrev_b32 v32, 16, v13
	v_and_b32 v33, 0xffff0000, v13
	s_barrier
	ds_read_b64_tr_b16 a[112:113], v16 offset:0
	ds_read_b64_tr_b16 a[114:115], v16 offset:1024
	ds_read_b64_tr_b16 a[116:117], v17 offset:0
	ds_read_b64_tr_b16 a[118:119], v17 offset:1024
	s_waitcnt vmcnt(12)
	v_add_f32_dpp v36, v100, v100 row_shl:4 row_mask:0xf bank_mask:0x5
	v_add_f32_dpp v37, v101, v101 row_shl:4 row_mask:0xf bank_mask:0x5
	v_add_f32_dpp v38, v102, v102 row_shl:4 row_mask:0xf bank_mask:0x5
	v_add_f32_dpp v39, v103, v103 row_shl:4 row_mask:0xf bank_mask:0x5
	v_add_f32_dpp v36, v100, v100 row_shr:4 row_mask:0xf bank_mask:0xa
	v_add_f32_dpp v37, v101, v101 row_shr:4 row_mask:0xf bank_mask:0xa
	v_add_f32_dpp v38, v102, v102 row_shr:4 row_mask:0xf bank_mask:0xa
	v_add_f32_dpp v39, v103, v103 row_shr:4 row_mask:0xf bank_mask:0xa
	v_cvt_pk_bf16_f32 v100, v36, v37
	v_cvt_pk_bf16_f32 v101, v38, v39
	s_waitcnt vmcnt(11)
	v_cvt_pk_bf16_f32 v68, v68, v69
	v_cvt_pk_bf16_f32 v69, v70, v71
	v_mov_b32 v70, v100
	v_mov_b32 v71, v101
	s_nop 0
	v_permlane16_swap_b32 v70, v68
	v_permlane16_swap_b32 v71, v69
	s_waitcnt vmcnt(10)
	s_nop 0
	v_mfma_f32_32x32x16_bf16 v[36:51], v[68:71], a[0:3], v[108:123]
	s_waitcnt vmcnt(9)
	v_mfma_f32_32x32x16_bf16 v[52:67], v[68:71], a[4:7], v[108:123]
	s_add_u32 s14, s14, 4096
	buffer_load_dwordx4 v[84:87], v5, s[44:47], s14 offen offset:0 sc1
	s_add_u32 s12, s12, 4096
	s_add_u32 s13, s13, 4096
	buffer_load_dwordx4 a[32:35], v5, s[44:47], s12 offen offset:0 sc1
	buffer_load_dwordx4 a[36:39], v5, s[44:47], s13 offen offset:0 sc1
	s_nop 3
	v_rcp_f32 v34, v36
	s_waitcnt vmcnt(11)
	v_cvt_pk_bf16_f32 v72, v72, v73
	v_cvt_pk_bf16_f32 v73, v74, v75
	v_mul_f32 v44, v34, v44
	v_mul_f32 v45, v34, v45
	v_mov_b32 v74, v100
	v_mov_b32 v75, v101
	v_cvt_pk_bf16_f32 v6, v44, v45
	v_mul_f32 v46, v34, v46
	v_mul_f32 v47, v34, v47
	v_cvt_pk_bf16_f32 v7, v46, v47
	v_mul_f32 v48, v34, v48
	v_permlane16_swap_b32 v74, v72
	v_permlane16_swap_b32 v75, v73
	v_mul_f32 v49, v34, v49
	v_cvt_pk_bf16_f32 v8, v48, v49
	v_mul_f32 v50, v34, v50
	v_mul_f32 v51, v34, v51
	v_cvt_pk_bf16_f32 v9, v50, v51
	s_waitcnt vmcnt(10)
	v_mfma_f32_32x32x16_bf16 v[36:51], v[72:75], a[8:11], v[108:123]
	v_rcp_f32 v35, v52
	ds_read_b64_tr_b16 a[120:121], v16 offset:2048
	v_mul_f32 v60, v35, v60
	v_mul_f32 v61, v35, v61
	v_cvt_pk_bf16_f32 v10, v60, v61
	s_waitcnt lgkmcnt(3)
	v_mfma_f32_32x32x16_bf16 v[18:33], a[112:115], v[6:9], v[18:33]
	v_mul_f32 v62, v35, v62
	v_mul_f32 v63, v35, v63
	v_cvt_pk_bf16_f32 v11, v62, v63
	v_mul_f32 v64, v35, v64
	v_mul_f32 v65, v35, v65
	ds_read_b64_tr_b16 a[122:123], v16 offset:3072
	s_waitcnt lgkmcnt(2)
	v_mfma_f32_32x32x16_bf16 a[80:95], a[116:119], v[6:9], 0
	ds_read_b64_tr_b16 a[124:125], v17 offset:2048
	ds_read_b64_tr_b16 a[126:127], v17 offset:3072
	v_cvt_pk_bf16_f32 v12, v64, v65
	v_mul_f32 v66, v35, v66
	v_mul_f32 v67, v35, v67
	v_cvt_pk_bf16_f32 v13, v66, v67
	s_waitcnt vmcnt(9)
	v_mfma_f32_32x32x16_bf16 v[52:67], v[72:75], a[12:15], v[108:123]
	buffer_load_dwordx4 v[88:91], v5, s[44:47], s14 offen offset:1024 sc1
	buffer_load_dwordx4 a[40:43], v5, s[44:47], s12 offen offset:1024 sc1
	buffer_load_dwordx4 a[44:47], v5, s[44:47], s13 offen offset:1024 sc1
	v_rcp_f32 v34, v37
	s_waitcnt vmcnt(11)
	v_cvt_pk_bf16_f32 v76, v76, v77
	v_cvt_pk_bf16_f32 v77, v78, v79
	v_mul_f32 v44, v34, v44
	v_mul_f32 v45, v34, v45
	v_mfma_f32_32x32x16_bf16 a[64:79], a[112:115], v[10:13], 0
	v_mov_b32 v78, v100
	v_mov_b32 v79, v101
	v_cvt_pk_bf16_f32 v6, v44, v45
	v_mul_f32 v46, v34, v46
	v_mul_f32 v47, v34, v47
	v_cvt_pk_bf16_f32 v7, v46, v47
	v_mul_f32 v48, v34, v48
	v_mfma_f32_32x32x16_bf16 a[96:111], a[116:119], v[10:13], 0
	v_permlane16_swap_b32 v78, v76
	v_permlane16_swap_b32 v79, v77
	v_mul_f32 v49, v34, v49
	v_cvt_pk_bf16_f32 v8, v48, v49
	v_mul_f32 v50, v34, v50
	v_mul_f32 v51, v34, v51
	v_cvt_pk_bf16_f32 v9, v50, v51
	s_waitcnt vmcnt(10)
	v_mfma_f32_32x32x16_bf16 v[36:51], v[76:79], a[16:19], v[108:123]
	v_rcp_f32 v35, v53
	ds_read_b64_tr_b16 a[112:113], v16 offset:4096
	v_mul_f32 v60, v35, v60
	v_mul_f32 v61, v35, v61
	v_cvt_pk_bf16_f32 v10, v60, v61
	s_waitcnt lgkmcnt(3)
	v_mfma_f32_32x32x16_bf16 v[18:33], a[120:123], v[6:9], v[18:33]
	v_mul_f32 v62, v35, v62
	v_mul_f32 v63, v35, v63
	v_cvt_pk_bf16_f32 v11, v62, v63
	v_mul_f32 v64, v35, v64
	v_mul_f32 v65, v35, v65
	ds_read_b64_tr_b16 a[114:115], v16 offset:5120
	s_waitcnt lgkmcnt(2)
	v_mfma_f32_32x32x16_bf16 a[80:95], a[124:127], v[6:9], a[80:95]
	ds_read_b64_tr_b16 a[116:117], v17 offset:4096
	ds_read_b64_tr_b16 a[118:119], v17 offset:5120
	v_cvt_pk_bf16_f32 v12, v64, v65
	v_mul_f32 v66, v35, v66
	v_mul_f32 v67, v35, v67
	v_cvt_pk_bf16_f32 v13, v66, v67
	s_waitcnt vmcnt(9)
	v_mfma_f32_32x32x16_bf16 v[52:67], v[76:79], a[20:23], v[108:123]
	buffer_load_dwordx4 v[92:95], v5, s[44:47], s14 offen offset:2048 sc1
	buffer_load_dwordx4 a[48:51], v5, s[44:47], s12 offen offset:2048 sc1
	buffer_load_dwordx4 a[52:55], v5, s[44:47], s13 offen offset:2048 sc1
	v_rcp_f32 v34, v38
	s_waitcnt vmcnt(11)
	v_cvt_pk_bf16_f32 v80, v80, v81
	v_cvt_pk_bf16_f32 v81, v82, v83
	v_mul_f32 v44, v34, v44
	v_mul_f32 v45, v34, v45
	v_mfma_f32_32x32x16_bf16 a[64:79], a[120:123], v[10:13], a[64:79]
	v_mov_b32 v82, v100
	v_mov_b32 v83, v101
	v_cvt_pk_bf16_f32 v6, v44, v45
	v_mul_f32 v46, v34, v46
	v_mul_f32 v47, v34, v47
	v_cvt_pk_bf16_f32 v7, v46, v47
	v_mul_f32 v48, v34, v48
	v_mfma_f32_32x32x16_bf16 a[96:111], a[124:127], v[10:13], a[96:111]
	v_permlane16_swap_b32 v82, v80
	v_permlane16_swap_b32 v83, v81
	v_mul_f32 v49, v34, v49
	v_cvt_pk_bf16_f32 v8, v48, v49
	v_mul_f32 v50, v34, v50
	v_mul_f32 v51, v34, v51
	v_cvt_pk_bf16_f32 v9, v50, v51
	s_waitcnt vmcnt(10)
	v_mfma_f32_32x32x16_bf16 v[36:51], v[80:83], a[24:27], v[108:123]
	v_rcp_f32 v35, v54
	ds_read_b64_tr_b16 a[120:121], v16 offset:6144
	v_mul_f32 v60, v35, v60
	v_mul_f32 v61, v35, v61
	v_cvt_pk_bf16_f32 v10, v60, v61
	s_waitcnt lgkmcnt(3)
	v_mfma_f32_32x32x16_bf16 v[18:33], a[112:115], v[6:9], v[18:33]
	v_mul_f32 v62, v35, v62
	v_mul_f32 v63, v35, v63
	v_cvt_pk_bf16_f32 v11, v62, v63
	v_mul_f32 v64, v35, v64
	v_mul_f32 v65, v35, v65
	ds_read_b64_tr_b16 a[122:123], v16 offset:7168
	s_waitcnt lgkmcnt(2)
	v_mfma_f32_32x32x16_bf16 a[80:95], a[116:119], v[6:9], a[80:95]
	ds_read_b64_tr_b16 a[124:125], v17 offset:6144
	ds_read_b64_tr_b16 a[126:127], v17 offset:7168
	v_cvt_pk_bf16_f32 v12, v64, v65
	v_mul_f32 v66, v35, v66
	v_mul_f32 v67, v35, v67
	v_cvt_pk_bf16_f32 v13, v66, v67
	s_waitcnt vmcnt(9)
	v_mfma_f32_32x32x16_bf16 v[52:67], v[80:83], a[28:31], v[108:123]
	buffer_load_dwordx4 v[96:99], v5, s[44:47], s14 offen offset:3072 sc1
	buffer_load_dwordx4 a[56:59], v5, s[44:47], s12 offen offset:3072 sc1
	buffer_load_dwordx4 a[60:63], v5, s[44:47], s13 offen offset:3072 sc1
	s_barrier
	v_rcp_f32 v34, v39
	s_waitcnt vmcnt(11)
	v_cvt_pk_bf16_f32 v84, v84, v85
	v_cvt_pk_bf16_f32 v85, v86, v87
	v_mul_f32 v44, v34, v44
	v_mul_f32 v45, v34, v45
	v_mfma_f32_32x32x16_bf16 a[64:79], a[112:115], v[10:13], a[64:79]
	v_mov_b32 v86, v100
	v_mov_b32 v87, v101
	v_cvt_pk_bf16_f32 v6, v44, v45
	v_mul_f32 v46, v34, v46
	v_mul_f32 v47, v34, v47
	v_cvt_pk_bf16_f32 v7, v46, v47
	v_mul_f32 v48, v34, v48
	v_mfma_f32_32x32x16_bf16 a[96:111], a[116:119], v[10:13], a[96:111]
	v_permlane16_swap_b32 v86, v84
	v_permlane16_swap_b32 v87, v85
	v_mul_f32 v49, v34, v49
	v_cvt_pk_bf16_f32 v8, v48, v49
	v_mul_f32 v50, v34, v50
	v_mul_f32 v51, v34, v51
	v_cvt_pk_bf16_f32 v9, v50, v51
	s_waitcnt vmcnt(10)
	v_mfma_f32_32x32x16_bf16 v[36:51], v[84:87], a[32:35], v[108:123]
	v_rcp_f32 v35, v55
	ds_read_b64_tr_b16 a[112:113], v16 offset:8192
	v_mul_f32 v60, v35, v60
	v_mul_f32 v61, v35, v61
	v_cvt_pk_bf16_f32 v10, v60, v61
	s_waitcnt lgkmcnt(3)
	v_mfma_f32_32x32x16_bf16 v[18:33], a[120:123], v[6:9], v[18:33]
	v_mul_f32 v62, v35, v62
	v_mul_f32 v63, v35, v63
	v_cvt_pk_bf16_f32 v11, v62, v63
	v_mul_f32 v64, v35, v64
	v_mul_f32 v65, v35, v65
	ds_read_b64_tr_b16 a[114:115], v16 offset:9216
	s_waitcnt lgkmcnt(2)
	v_mfma_f32_32x32x16_bf16 a[80:95], a[124:127], v[6:9], a[80:95]
	ds_read_b64_tr_b16 a[116:117], v17 offset:8192
	ds_read_b64_tr_b16 a[118:119], v17 offset:9216
	v_cvt_pk_bf16_f32 v12, v64, v65
	v_mul_f32 v66, v35, v66
	v_mul_f32 v67, v35, v67
	v_cvt_pk_bf16_f32 v13, v66, v67
	s_waitcnt vmcnt(9)
	v_mfma_f32_32x32x16_bf16 v[52:67], v[84:87], a[36:39], v[108:123]
	v_rcp_f32 v34, v40
	s_waitcnt vmcnt(8)
	v_cvt_pk_bf16_f32 v88, v88, v89
	v_cvt_pk_bf16_f32 v89, v90, v91
	v_mul_f32 v44, v34, v44
	v_mul_f32 v45, v34, v45
	v_mfma_f32_32x32x16_bf16 a[64:79], a[120:123], v[10:13], a[64:79]
	v_mov_b32 v90, v100
	v_mov_b32 v91, v101
	v_cvt_pk_bf16_f32 v6, v44, v45
	v_mul_f32 v46, v34, v46
	v_mul_f32 v47, v34, v47
	v_cvt_pk_bf16_f32 v7, v46, v47
	v_mul_f32 v48, v34, v48
	v_mfma_f32_32x32x16_bf16 a[96:111], a[124:127], v[10:13], a[96:111]
	v_permlane16_swap_b32 v90, v88
	v_permlane16_swap_b32 v91, v89
	v_mul_f32 v49, v34, v49
	v_cvt_pk_bf16_f32 v8, v48, v49
	v_mul_f32 v50, v34, v50
	v_mul_f32 v51, v34, v51
	v_cvt_pk_bf16_f32 v9, v50, v51
	s_waitcnt vmcnt(7)
	v_mfma_f32_32x32x16_bf16 v[36:51], v[88:91], a[40:43], v[108:123]
	v_rcp_f32 v35, v56
	ds_read_b64_tr_b16 a[120:121], v16 offset:10240
	v_mul_f32 v60, v35, v60
	v_mul_f32 v61, v35, v61
	v_cvt_pk_bf16_f32 v10, v60, v61
	s_waitcnt lgkmcnt(3)
	v_mfma_f32_32x32x16_bf16 v[18:33], a[112:115], v[6:9], v[18:33]
	v_mul_f32 v62, v35, v62
	v_mul_f32 v63, v35, v63
	v_cvt_pk_bf16_f32 v11, v62, v63
	v_mul_f32 v64, v35, v64
	v_mul_f32 v65, v35, v65
	ds_read_b64_tr_b16 a[122:123], v16 offset:11264
	s_waitcnt lgkmcnt(2)
	v_mfma_f32_32x32x16_bf16 a[80:95], a[116:119], v[6:9], a[80:95]
	ds_read_b64_tr_b16 a[124:125], v17 offset:10240
	ds_read_b64_tr_b16 a[126:127], v17 offset:11264
	v_cvt_pk_bf16_f32 v12, v64, v65
	v_mul_f32 v66, v35, v66
	v_mul_f32 v67, v35, v67
	v_cvt_pk_bf16_f32 v13, v66, v67
	s_waitcnt vmcnt(6)
	v_mfma_f32_32x32x16_bf16 v[52:67], v[88:91], a[44:47], v[108:123]
	v_rcp_f32 v34, v41
	s_waitcnt vmcnt(5)
	v_cvt_pk_bf16_f32 v92, v92, v93
	v_cvt_pk_bf16_f32 v93, v94, v95
	v_mul_f32 v44, v34, v44
	v_mul_f32 v45, v34, v45
	v_mfma_f32_32x32x16_bf16 a[64:79], a[112:115], v[10:13], a[64:79]
	v_mov_b32 v94, v100
	v_mov_b32 v95, v101
	v_cvt_pk_bf16_f32 v6, v44, v45
	v_mul_f32 v46, v34, v46
	v_mul_f32 v47, v34, v47
	v_cvt_pk_bf16_f32 v7, v46, v47
	v_mul_f32 v48, v34, v48
	v_mfma_f32_32x32x16_bf16 a[96:111], a[116:119], v[10:13], a[96:111]
	v_permlane16_swap_b32 v94, v92
	v_permlane16_swap_b32 v95, v93
	v_mul_f32 v49, v34, v49
	v_cvt_pk_bf16_f32 v8, v48, v49
	v_mul_f32 v50, v34, v50
	v_mul_f32 v51, v34, v51
	v_cvt_pk_bf16_f32 v9, v50, v51
	s_waitcnt vmcnt(4)
	v_mfma_f32_32x32x16_bf16 v[36:51], v[92:95], a[48:51], v[108:123]
	v_rcp_f32 v35, v57
	ds_read_b64_tr_b16 a[112:113], v16 offset:12288
	v_mul_f32 v60, v35, v60
	v_mul_f32 v61, v35, v61
	v_cvt_pk_bf16_f32 v10, v60, v61
	s_waitcnt lgkmcnt(3)
	v_mfma_f32_32x32x16_bf16 v[18:33], a[120:123], v[6:9], v[18:33]
	v_mul_f32 v62, v35, v62
	v_mul_f32 v63, v35, v63
	v_cvt_pk_bf16_f32 v11, v62, v63
	v_mul_f32 v64, v35, v64
	v_mul_f32 v65, v35, v65
	ds_read_b64_tr_b16 a[114:115], v16 offset:13312
	s_waitcnt lgkmcnt(2)
	v_mfma_f32_32x32x16_bf16 a[80:95], a[124:127], v[6:9], a[80:95]
	ds_read_b64_tr_b16 a[116:117], v17 offset:12288
	ds_read_b64_tr_b16 a[118:119], v17 offset:13312
	v_cvt_pk_bf16_f32 v12, v64, v65
	v_mul_f32 v66, v35, v66
	v_mul_f32 v67, v35, v67
	v_cvt_pk_bf16_f32 v13, v66, v67
	s_waitcnt vmcnt(3)
	v_mfma_f32_32x32x16_bf16 v[52:67], v[92:95], a[52:55], v[108:123]
	v_rcp_f32 v34, v42
	s_waitcnt vmcnt(2)
	v_cvt_pk_bf16_f32 v96, v96, v97
	v_cvt_pk_bf16_f32 v97, v98, v99
	v_mul_f32 v44, v34, v44
	v_mul_f32 v45, v34, v45
	v_mfma_f32_32x32x16_bf16 a[64:79], a[120:123], v[10:13], a[64:79]
	v_mov_b32 v98, v100
	v_mov_b32 v99, v101
	v_cvt_pk_bf16_f32 v6, v44, v45
	v_mul_f32 v46, v34, v46
	v_mul_f32 v47, v34, v47
	v_cvt_pk_bf16_f32 v7, v46, v47
	v_mul_f32 v48, v34, v48
	v_mfma_f32_32x32x16_bf16 a[96:111], a[124:127], v[10:13], a[96:111]
	v_permlane16_swap_b32 v98, v96
	v_permlane16_swap_b32 v99, v97
	v_mul_f32 v49, v34, v49
	v_cvt_pk_bf16_f32 v8, v48, v49
	v_mul_f32 v50, v34, v50
	v_mul_f32 v51, v34, v51
	v_cvt_pk_bf16_f32 v9, v50, v51
	s_waitcnt vmcnt(1)
	v_mfma_f32_32x32x16_bf16 v[36:51], v[96:99], a[56:59], v[108:123]
	v_rcp_f32 v35, v58
	ds_read_b64_tr_b16 a[120:121], v16 offset:14336
	v_mul_f32 v60, v35, v60
	v_mul_f32 v61, v35, v61
	v_cvt_pk_bf16_f32 v10, v60, v61
	s_waitcnt lgkmcnt(3)
	v_mfma_f32_32x32x16_bf16 v[18:33], a[112:115], v[6:9], v[18:33]
	v_mul_f32 v62, v35, v62
	v_mul_f32 v63, v35, v63
	v_cvt_pk_bf16_f32 v11, v62, v63
	v_mul_f32 v64, v35, v64
	v_mul_f32 v65, v35, v65
	ds_read_b64_tr_b16 a[122:123], v16 offset:15360
	s_waitcnt lgkmcnt(2)
	v_mfma_f32_32x32x16_bf16 a[80:95], a[116:119], v[6:9], a[80:95]
	ds_read_b64_tr_b16 a[124:125], v17 offset:14336
	ds_read_b64_tr_b16 a[126:127], v17 offset:15360
	v_cvt_pk_bf16_f32 v12, v64, v65
	v_mul_f32 v66, v35, v66
	v_mul_f32 v67, v35, v67
	v_cvt_pk_bf16_f32 v13, v66, v67
	s_waitcnt vmcnt(0)
	v_mfma_f32_32x32x16_bf16 v[52:67], v[96:99], a[60:63], v[108:123]
	v_rcp_f32 v34, v43
	s_nop 0
	v_mul_f32 v44, v34, v44
	v_mul_f32 v45, v34, v45
	v_mfma_f32_32x32x16_bf16 a[64:79], a[112:115], v[10:13], a[64:79]
	v_cvt_pk_bf16_f32 v6, v44, v45
	v_mul_f32 v46, v34, v46
	v_mul_f32 v47, v34, v47
	v_cvt_pk_bf16_f32 v7, v46, v47
	v_mul_f32 v48, v34, v48
	v_mfma_f32_32x32x16_bf16 a[96:111], a[116:119], v[10:13], a[96:111]
	v_mul_f32 v49, v34, v49
	v_cvt_pk_bf16_f32 v8, v48, v49
	v_mul_f32 v50, v34, v50
	v_mul_f32 v51, v34, v51
	v_cvt_pk_bf16_f32 v9, v50, v51
	v_rcp_f32 v35, v59
	s_nop 0
	v_mul_f32 v60, v35, v60
	v_mul_f32 v61, v35, v61
	v_cvt_pk_bf16_f32 v10, v60, v61
	s_waitcnt lgkmcnt(2)
	v_mfma_f32_32x32x16_bf16 v[18:33], a[120:123], v[6:9], v[18:33]
	v_mul_f32 v62, v35, v62
	v_mul_f32 v63, v35, v63
	v_cvt_pk_bf16_f32 v11, v62, v63
	v_mul_f32 v64, v35, v64
	v_mul_f32 v65, v35, v65
	s_waitcnt lgkmcnt(0)
	v_mfma_f32_32x32x16_bf16 a[80:95], a[124:127], v[6:9], a[80:95]
	v_cvt_pk_bf16_f32 v12, v64, v65
	v_mul_f32 v66, v35, v66
	v_mul_f32 v67, v35, v67
	v_cvt_pk_bf16_f32 v13, v66, v67
	s_nop 1
	v_mfma_f32_32x32x16_bf16 a[64:79], a[120:123], v[10:13], a[64:79]
	v_mfma_f32_32x32x16_bf16 a[96:111], a[124:127], v[10:13], a[96:111]
	s_nop 3
	ds_write_b128 v104, a[80:83] offset:4096
	ds_write_b128 v104, a[84:87] offset:5120
	ds_write_b128 v104, a[88:91] offset:6144
	ds_write_b128 v104, a[92:95] offset:7168
	s_nop 2
	ds_write_b128 v104, a[64:67] offset:0
	ds_write_b128 v104, a[68:71] offset:1024
	ds_write_b128 v104, a[72:75] offset:2048
	ds_write_b128 v104, a[76:79] offset:3072
	ds_write_b128 v104, a[96:99] offset:8192
	ds_write_b128 v104, a[100:103] offset:9216
	ds_write_b128 v104, a[104:107] offset:10240
	ds_write_b128 v104, a[108:111] offset:11264
	s_lshl_b32 s50, s52, 9
	s_add_u32 s50, s50, 10534976
	s_add_u32 s68, s44, s50
	s_addc_u32 s69, s45, 0
	s_lshl_b32 s50, s5, 1
	s_add_u32 s50, s50, s53
	s_lshl_b32 s51, s52, 4
	s_add_u32 s51, s51, s50
	s_lshl_b32 s50, s51, 11
	s_add_u32 s50, s50, 2097152
	s_lshl_b32 s51, s51, 8
	s_add_u32 s51, s51, 11534336
	v_mov_b32 v84, 0
	v_mov_b32 v85, 0
	v_lshlrev_b32 v2, 3, v0
	s_waitcnt lgkmcnt(0)
	s_barrier
	ds_read_b128 v[36:39], v105 offset:0
	ds_read_b128 v[52:55], v106 offset:0
	ds_read_b128 v[68:71], v107 offset:0
	ds_read_b128 v[40:43], v105 offset:1024
	ds_read_b128 v[56:59], v106 offset:1024
	ds_read_b128 v[72:75], v107 offset:1024
	ds_read_b128 v[44:47], v105 offset:2048
	ds_read_b128 v[60:63], v106 offset:2048
	ds_read_b128 v[76:79], v107 offset:2048
	ds_read_b128 v[48:51], v105 offset:3072
	ds_read_b128 v[64:67], v106 offset:3072
	ds_read_b128 v[80:83], v107 offset:3072
	s_waitcnt lgkmcnt(11)
	v_pk_add_f32 v[18:19], v[18:19], v[36:37]
	v_pk_add_f32 v[20:21], v[20:21], v[38:39]
	s_waitcnt lgkmcnt(10)
	v_pk_add_f32 v[18:19], v[18:19], v[52:53]
	v_pk_add_f32 v[20:21], v[20:21], v[54:55]
	s_waitcnt lgkmcnt(9)
	v_pk_add_f32 v[18:19], v[18:19], v[68:69]
	v_pk_add_f32 v[20:21], v[20:21], v[70:71]
	v_cvt_pk_bf16_f32 v6, v18, v19
	v_cvt_pk_bf16_f32 v7, v20, v21
	v_dot2c_f32_bf16 v84, s6, v6
	v_dot2c_f32_bf16 v85, v6, v6
	v_dot2c_f32_bf16 v84, s6, v7
	v_dot2c_f32_bf16 v85, v7, v7
	s_waitcnt lgkmcnt(8)
	v_pk_add_f32 v[22:23], v[22:23], v[40:41]
	v_pk_add_f32 v[24:25], v[24:25], v[42:43]
	s_waitcnt lgkmcnt(7)
	v_pk_add_f32 v[22:23], v[22:23], v[56:57]
	v_pk_add_f32 v[24:25], v[24:25], v[58:59]
	s_waitcnt lgkmcnt(6)
	v_pk_add_f32 v[22:23], v[22:23], v[72:73]
	v_pk_add_f32 v[24:25], v[24:25], v[74:75]
	v_cvt_pk_bf16_f32 v8, v22, v23
	v_cvt_pk_bf16_f32 v9, v24, v25
	buffer_store_dwordx4 v[6:9], v5, s[44:47], s50 offen offset:0 sc1
	v_dot2c_f32_bf16 v84, s6, v8
	v_dot2c_f32_bf16 v85, v8, v8
	v_dot2c_f32_bf16 v84, s6, v9
	v_dot2c_f32_bf16 v85, v9, v9
	s_waitcnt lgkmcnt(5)
	v_pk_add_f32 v[26:27], v[26:27], v[44:45]
	v_pk_add_f32 v[28:29], v[28:29], v[46:47]
	s_waitcnt lgkmcnt(4)
	v_pk_add_f32 v[26:27], v[26:27], v[60:61]
	v_pk_add_f32 v[28:29], v[28:29], v[62:63]
	s_waitcnt lgkmcnt(3)
	v_pk_add_f32 v[26:27], v[26:27], v[76:77]
	v_pk_add_f32 v[28:29], v[28:29], v[78:79]
	v_cvt_pk_bf16_f32 v10, v26, v27
	v_cvt_pk_bf16_f32 v11, v28, v29
	v_dot2c_f32_bf16 v84, s6, v10
	v_dot2c_f32_bf16 v85, v10, v10
	v_dot2c_f32_bf16 v84, s6, v11
	v_dot2c_f32_bf16 v85, v11, v11
	s_waitcnt lgkmcnt(2)
	v_pk_add_f32 v[30:31], v[30:31], v[48:49]
	v_pk_add_f32 v[32:33], v[32:33], v[50:51]
	s_waitcnt lgkmcnt(1)
	v_pk_add_f32 v[30:31], v[30:31], v[64:65]
	v_pk_add_f32 v[32:33], v[32:33], v[66:67]
	s_waitcnt lgkmcnt(0)
	v_pk_add_f32 v[30:31], v[30:31], v[80:81]
	v_pk_add_f32 v[32:33], v[32:33], v[82:83]
	v_cvt_pk_bf16_f32 v12, v30, v31
	v_cvt_pk_bf16_f32 v13, v32, v33
	buffer_store_dwordx4 v[10:13], v5, s[44:47], s50 offen offset:1024 sc1
	v_dot2c_f32_bf16 v84, s6, v12
	v_dot2c_f32_bf16 v85, v12, v12
	v_dot2c_f32_bf16 v84, s6, v13
	v_dot2c_f32_bf16 v85, v13, v13
	s_nop 1
	v_mov_b32 v86, v84
	v_mov_b32 v87, v85
	s_nop 0
	v_permlane32_swap_b32 v84, v86
	v_permlane32_swap_b32 v85, v87
	v_pk_add_f32 v[84:85], v[84:85], v[86:87]
	s_mov_b32 exec_hi, 0
	buffer_store_dwordx2 v[84:85], v2, s[44:47], s51 offen sc1
	s_mov_b64 exec, -1
	s_barrier
	s_lshr_b32 s55, s7, 1
	s_lshl_b32 s55, s55, 2
	s_add_u32 s55, s55, s3
	s_lshl_b32 s56, s55, 15
	s_add_u32 s56, s56, 2097152
	s_lshl_b32 s57, s55, 12
	s_add_u32 s57, s57, 11534336
	s_lshl_b32 s50, s55, 1
	s_and_b32 s51, s7, 1
	s_add_u32 s50, s50, s51
	s_lshl_b32 s50, s50, 8
	s_add_u32 s50, s50, 10534976
	s_add_u32 s70, s44, s50
	s_addc_u32 s71, s45, 0
	v_bfe_u32 v2, v0, 2, 2
	v_lshrrev_b32 v3, 5, v0
	v_lshl_add_u32 v3, v3, 2, v2
	v_mul_u32_u24 v3, 192, v3
	v_and_b32 v4, 3, v0
	v_lshl_add_u32 v3, v4, 3, v3
	v_bfe_u32 v4, v0, 4, 1
	v_lshl_add_u32 v14, v4, 5, v3
	v_add_u32 v15, 49152, v14
	v_and_b32 v2, 31, v0
	v_lshrrev_b32 v3, 5, v0
	v_lshlrev_b32 v4, 1, v2
	v_lshlrev_b32 v2, 3, v2
	v_lshl_add_u32 v18, v3, 11, v2
	s_lshl_b32 s58, s49, 6
	buffer_load_ushort v22, v4, s[24:27], s58 offen offset:0
	buffer_load_ushort v26, v4, s[24:27], s58 offen offset:64
	buffer_load_ushort v30, v4, s[24:27], s58 offen offset:128
	s_lshl_b32 s50, s5, 1
	s_add_u32 s50, s50, s53
	s_lshl_b32 s50, s50, 6
	v_lshlrev_b32 v3, 3, v3
	buffer_load_dwordx2 v[40:41], v3, s[32:35], s50 offen offset:0
	buffer_load_dwordx2 v[42:43], v3, s[32:35], s50 offen offset:16
	buffer_load_dwordx2 v[44:45], v3, s[32:35], s50 offen offset:32
	buffer_load_dwordx2 v[46:47], v3, s[32:35], s50 offen offset:48
	s_lshl_b32 s50, s53, 15
	s_add_u32 s50, s50, 98304
	s_sub_u32 s50, s50, s54
	v_add_u32 v16, s50, v16
	v_add_u32 v17, s50, v17
	v_add_u32 v19, 129024, v5
	ds_read_b64_tr_b16 a[92:93], v14 offset:0
	ds_read_b64_tr_b16 a[94:95], v14 offset:1536
	ds_read_b64_tr_b16 a[96:97], v14 offset:64
	ds_read_b64_tr_b16 a[98:99], v14 offset:1600
	ds_read_b64_tr_b16 a[100:101], v14 offset:3072
	ds_read_b64_tr_b16 a[102:103], v14 offset:4608
	ds_read_b64_tr_b16 a[104:105], v14 offset:3136
	ds_read_b64_tr_b16 a[106:107], v14 offset:4672
	ds_read_b64_tr_b16 a[108:109], v14 offset:128
	ds_read_b64_tr_b16 a[110:111], v14 offset:1664
	s_waitcnt vmcnt(7)
	s_atomic_add s66, s[68:69], 0
	s_atomic_add s66, s[68:69], 256
	s_mov_b32 s59, 0
L_h_poll:
	s_mov_b32 s60, 0
	s_atomic_add s60, s[70:71], 0 glc
	s_add_u32 s59, s59, 1
	s_waitcnt lgkmcnt(0)
	s_cmp_ge_u32 s60, 16
	s_cbranch_scc1 L_h_done
	s_cmp_lt_u32 s59, 262144
	s_cbranch_scc1 L_h_poll
L_h_done:
	buffer_load_dwordx4 a[0:3], v5, s[44:47], s56 offen offset:0 sc1
	buffer_load_dwordx4 a[4:7], v5, s[44:47], s56 offen offset:1024 sc1
	buffer_load_dwordx4 a[8:11], v5, s[44:47], s56 offen offset:2048 sc1
	buffer_load_dwordx4 a[12:15], v5, s[44:47], s56 offen offset:3072 sc1
	s_add_u32 s56, s56, 4096
	buffer_load_dwordx4 a[16:19], v5, s[44:47], s56 offen offset:0 sc1
	buffer_load_dwordx4 a[20:23], v5, s[44:47], s56 offen offset:1024 sc1
	buffer_load_dwordx4 a[24:27], v5, s[44:47], s56 offen offset:2048 sc1
	buffer_load_dwordx4 a[28:31], v5, s[44:47], s56 offen offset:3072 sc1
	s_add_u32 s56, s56, 4096
	buffer_load_dwordx4 a[32:35], v5, s[44:47], s56 offen offset:0 sc1
	buffer_load_dwordx4 a[36:39], v5, s[44:47], s56 offen offset:1024 sc1
	buffer_load_dwordx4 a[40:43], v5, s[44:47], s56 offen offset:2048 sc1
	buffer_load_dwordx4 a[44:47], v5, s[44:47], s56 offen offset:3072 sc1
	s_add_u32 s56, s56, 4096
	s_mul_i32 s58, s55, 88
	s_add_u32 s58, s58, s65
	s_lshl_b32 s58, s58, 10
	s_add_u32 s58, s58, 4194304
	s_cmp_ge_u32 s65, 44
	s_cselect_b32 s51, 256, 0
	s_lshl_b32 s50, s55, 9
	s_add_u32 s50, s50, s51
	s_add_u32 s50, s50, 10535104
	s_add_u32 s68, s44, s50
	s_addc_u32 s69, s45, 0
	s_lshl_b32 s50, s52, 1
	s_add_u32 s50, s50, s53
	s_mul_i32 s67, s50, 45056
	s_add_u32 s67, s67, 4194304
	s_lshl_b32 s50, s50, 8
	s_add_u32 s65, s50, 10535104
	s_add_u32 s70, s44, s65
	s_addc_u32 s71, s45, 0
	s_mov_b32 s62, 0x100
	s_mov_b32 s63, 0x10000
	s_waitcnt vmcnt(11)
	v_mfma_f32_32x32x16_bf16 v[48:63], a[92:95], a[0:3], 0
	ds_read_b64_tr_b16 a[112:113], v14 offset:6144
	ds_read_b64_tr_b16 a[114:115], v14 offset:7680
	buffer_load_dwordx4 a[48:51], v5, s[44:47], s56 offen offset:0 sc1
	v_mfma_f32_32x32x16_bf16 v[64:79], a[96:99], a[0:3], 0
	ds_read_b64_tr_b16 a[116:117], v14 offset:6208
	ds_read_b64_tr_b16 a[118:119], v14 offset:7744
	s_waitcnt vmcnt(11)
	v_mfma_f32_32x32x16_bf16 v[48:63], a[100:103], a[4:7], v[48:63]
	ds_read_b64_tr_b16 a[120:121], v14 offset:9216
	ds_read_b64_tr_b16 a[122:123], v14 offset:10752
	buffer_load_dwordx4 a[52:55], v5, s[44:47], s56 offen offset:1024 sc1
	v_mfma_f32_32x32x16_bf16 v[64:79], a[104:107], a[4:7], v[64:79]
	ds_read_b64_tr_b16 a[92:93], v14 offset:9280
	ds_read_b64_tr_b16 a[94:95], v14 offset:10816
	s_waitcnt lgkmcnt(6)
	v_mfma_f32_32x32x16_bf16 v[80:95], a[108:111], a[0:3], 0
	ds_read_b64_tr_b16 a[96:97], v14 offset:3200
	ds_read_b64_tr_b16 a[98:99], v14 offset:4736
	s_waitcnt vmcnt(11)
	v_mfma_f32_32x32x16_bf16 v[48:63], a[112:115], a[8:11], v[48:63]
	ds_read_b64_tr_b16 a[100:101], v14 offset:12288
	ds_read_b64_tr_b16 a[102:103], v14 offset:13824
	buffer_load_dwordx4 a[56:59], v5, s[44:47], s56 offen offset:2048 sc1
	s_waitcnt lgkmcnt(6)
	v_mfma_f32_32x32x16_bf16 v[64:79], a[116:119], a[8:11], v[64:79]
	ds_read_b64_tr_b16 a[104:105], v14 offset:12352
	ds_read_b64_tr_b16 a[106:107], v14 offset:13888
	s_waitcnt vmcnt(11)
	v_mfma_f32_32x32x16_bf16 v[48:63], a[120:123], a[12:15], v[48:63]
	ds_read_b64_tr_b16 a[108:109], v14 offset:15360
	ds_read_b64_tr_b16 a[110:111], v14 offset:16896
	buffer_load_dwordx4 a[60:63], v5, s[44:47], s56 offen offset:3072 sc1
	s_add_u32 s56, s56, 4096
	s_waitcnt lgkmcnt(6)
	v_mfma_f32_32x32x16_bf16 v[64:79], a[92:95], a[12:15], v[64:79]
	ds_read_b64_tr_b16 a[112:113], v14 offset:15424
	ds_read_b64_tr_b16 a[114:115], v14 offset:16960
	v_mfma_f32_32x32x16_bf16 v[80:95], a[96:99], a[4:7], v[80:95]
	ds_read_b64_tr_b16 a[116:117], v14 offset:6272
	ds_read_b64_tr_b16 a[118:119], v14 offset:7808
	s_waitcnt vmcnt(11) lgkmcnt(6)
	v_mfma_f32_32x32x16_bf16 v[48:63], a[100:103], a[16:19], v[48:63]
	ds_read_b64_tr_b16 a[120:121], v14 offset:18432
	ds_read_b64_tr_b16 a[122:123], v14 offset:19968
	buffer_load_dwordx4 a[64:67], v5, s[44:47], s56 offen offset:0 sc1
	v_mfma_f32_32x32x16_bf16 v[64:79], a[104:107], a[16:19], v[64:79]
	ds_read_b64_tr_b16 a[92:93], v14 offset:18496
	ds_read_b64_tr_b16 a[94:95], v14 offset:20032
	buffer_load_dwordx2 v[96:97], v18, s[44:47], s57 offen offset:0 sc1
	s_waitcnt vmcnt(12) lgkmcnt(6)
	v_mfma_f32_32x32x16_bf16 v[48:63], a[108:111], a[20:23], v[48:63]
	ds_read_b64_tr_b16 a[96:97], v14 offset:21504
	ds_read_b64_tr_b16 a[98:99], v14 offset:23040
	buffer_load_dwordx4 a[68:71], v5, s[44:47], s56 offen offset:1024 sc1
	v_mfma_f32_32x32x16_bf16 v[64:79], a[112:115], a[20:23], v[64:79]
	ds_read_b64_tr_b16 a[100:101], v14 offset:21568
	ds_read_b64_tr_b16 a[102:103], v14 offset:23104
	buffer_load_dwordx2 v[98:99], v18, s[44:47], s57 offen offset:256 sc1
	s_waitcnt lgkmcnt(6)
	v_mfma_f32_32x32x16_bf16 v[80:95], a[116:119], a[8:11], v[80:95]
	ds_read_b64_tr_b16 a[104:105], v14 offset:9344
	ds_read_b64_tr_b16 a[106:107], v14 offset:10880
	s_waitcnt vmcnt(13)
	v_mfma_f32_32x32x16_bf16 v[48:63], a[120:123], a[24:27], v[48:63]
	ds_read_b64_tr_b16 a[108:109], v14 offset:24576
	ds_read_b64_tr_b16 a[110:111], v14 offset:26112
	buffer_load_dwordx4 a[72:75], v5, s[44:47], s56 offen offset:2048 sc1
	s_waitcnt lgkmcnt(6)
	v_mfma_f32_32x32x16_bf16 v[64:79], a[92:95], a[24:27], v[64:79]
	ds_read_b64_tr_b16 a[112:113], v14 offset:24640
	ds_read_b64_tr_b16 a[114:115], v14 offset:26176
	buffer_load_dwordx2 v[100:101], v18, s[44:47], s57 offen offset:512 sc1
	s_waitcnt vmcnt(14)
	v_mfma_f32_32x32x16_bf16 v[48:63], a[96:99], a[28:31], v[48:63]
	ds_read_b64_tr_b16 a[116:117], v14 offset:27648
	ds_read_b64_tr_b16 a[118:119], v14 offset:29184
	buffer_load_dwordx4 a[76:79], v5, s[44:47], s56 offen offset:3072 sc1
	s_add_u32 s56, s56, 4096
	s_waitcnt lgkmcnt(6)
	v_mfma_f32_32x32x16_bf16 v[64:79], a[100:103], a[28:31], v[64:79]
	ds_read_b64_tr_b16 a[120:121], v14 offset:27712
	ds_read_b64_tr_b16 a[122:123], v14 offset:29248
	buffer_load_dwordx2 v[102:103], v18, s[44:47], s57 offen offset:768 sc1
	v_mfma_f32_32x32x16_bf16 v[80:95], a[104:107], a[12:15], v[80:95]
	ds_read_b64_tr_b16 a[92:93], v14 offset:12416
	ds_read_b64_tr_b16 a[94:95], v14 offset:13952
	s_waitcnt vmcnt(15) lgkmcnt(6)
	v_mfma_f32_32x32x16_bf16 v[48:63], a[108:111], a[32:35], v[48:63]
	ds_read_b64_tr_b16 a[96:97], v14 offset:30720
	ds_read_b64_tr_b16 a[98:99], v14 offset:32256
	buffer_load_dwordx4 a[80:83], v5, s[44:47], s56 offen offset:0 sc1
	v_mfma_f32_32x32x16_bf16 v[64:79], a[112:115], a[32:35], v[64:79]
	ds_read_b64_tr_b16 a[100:101], v14 offset:30784
	ds_read_b64_tr_b16 a[102:103], v14 offset:32320
	buffer_load_dwordx2 v[104:105], v18, s[44:47], s57 offen offset:1024 sc1
	s_waitcnt vmcnt(16) lgkmcnt(6)
	v_mfma_f32_32x32x16_bf16 v[48:63], a[116:119], a[36:39], v[48:63]
	ds_read_b64_tr_b16 a[104:105], v14 offset:33792
	ds_read_b64_tr_b16 a[106:107], v14 offset:35328
	buffer_load_dwordx4 a[84:87], v5, s[44:47], s56 offen offset:1024 sc1
	v_mfma_f32_32x32x16_bf16 v[64:79], a[120:123], a[36:39], v[64:79]
	ds_read_b64_tr_b16 a[108:109], v14 offset:33856
	ds_read_b64_tr_b16 a[110:111], v14 offset:35392
	buffer_load_dwordx2 v[106:107], v18, s[44:47], s57 offen offset:1280 sc1
	s_waitcnt lgkmcnt(6)
	v_mfma_f32_32x32x16_bf16 v[80:95], a[92:95], a[16:19], v[80:95]
	ds_read_b64_tr_b16 a[112:113], v14 offset:15488
	ds_read_b64_tr_b16 a[114:115], v14 offset:17024
	s_waitcnt vmcnt(17)
	v_mfma_f32_32x32x16_bf16 v[48:63], a[96:99], a[40:43], v[48:63]
	ds_read_b64_tr_b16 a[116:117], v14 offset:36864
	ds_read_b64_tr_b16 a[118:119], v14 offset:38400
	buffer_load_dwordx4 a[88:91], v5, s[44:47], s56 offen offset:2048 sc1
	s_waitcnt lgkmcnt(6)
	v_mfma_f32_32x32x16_bf16 v[64:79], a[100:103], a[40:43], v[64:79]
	ds_read_b64_tr_b16 a[120:121], v14 offset:36928
	ds_read_b64_tr_b16 a[122:123], v14 offset:38464
	buffer_load_dwordx2 v[108:109], v18, s[44:47], s57 offen offset:1536 sc1
	s_waitcnt vmcnt(18)
	v_mfma_f32_32x32x16_bf16 v[48:63], a[104:107], a[44:47], v[48:63]
	ds_read_b64_tr_b16 a[92:93], v14 offset:39936
	ds_read_b64_tr_b16 a[94:95], v14 offset:41472
	buffer_load_dwordx4 a[0:3], v5, s[44:47], s56 offen offset:3072 sc1
	s_add_u32 s56, s56, 4096
	s_waitcnt lgkmcnt(6)
	v_mfma_f32_32x32x16_bf16 v[64:79], a[108:111], a[44:47], v[64:79]
	ds_read_b64_tr_b16 a[96:97], v14 offset:40000
	ds_read_b64_tr_b16 a[98:99], v14 offset:41536
	buffer_load_dwordx2 v[110:111], v18, s[44:47], s57 offen offset:1792 sc1
	v_mfma_f32_32x32x16_bf16 v[80:95], a[112:115], a[20:23], v[80:95]
	ds_read_b64_tr_b16 a[100:101], v14 offset:18560
	ds_read_b64_tr_b16 a[102:103], v14 offset:20096
	s_waitcnt vmcnt(19) lgkmcnt(6)
	v_mfma_f32_32x32x16_bf16 v[48:63], a[116:119], a[48:51], v[48:63]
	ds_read_b64_tr_b16 a[104:105], v14 offset:43008
	ds_read_b64_tr_b16 a[106:107], v14 offset:44544
	buffer_load_dwordx4 a[4:7], v5, s[44:47], s56 offen offset:0 sc1
	s_barrier
	v_mfma_f32_32x32x16_bf16 v[64:79], a[120:123], a[48:51], v[64:79]
	ds_read_b64_tr_b16 a[108:109], v14 offset:43072
	ds_read_b64_tr_b16 a[110:111], v14 offset:44608
	s_waitcnt vmcnt(19) lgkmcnt(6)
	v_mfma_f32_32x32x16_bf16 v[48:63], a[92:95], a[52:55], v[48:63]
	ds_read_b64_tr_b16 a[112:113], v14 offset:46080
	ds_read_b64_tr_b16 a[114:115], v14 offset:47616
	buffer_load_dwordx4 a[8:11], v5, s[44:47], s56 offen offset:1024 sc1
	v_mfma_f32_32x32x16_bf16 v[64:79], a[96:99], a[52:55], v[64:79]
	ds_read_b64_tr_b16 a[116:117], v14 offset:46144
	ds_read_b64_tr_b16 a[118:119], v14 offset:47680
	s_waitcnt lgkmcnt(6)
	v_mfma_f32_32x32x16_bf16 v[80:95], a[100:103], a[24:27], v[80:95]
	ds_read_b64_tr_b16 a[120:121], v14 offset:21632
	ds_read_b64_tr_b16 a[122:123], v14 offset:23168
	s_waitcnt vmcnt(19)
	v_mfma_f32_32x32x16_bf16 v[48:63], a[104:107], a[56:59], v[48:63]
	ds_read_b64_tr_b16 a[92:93], v15 offset:0
	ds_read_b64_tr_b16 a[94:95], v15 offset:1536
	buffer_load_dwordx4 a[12:15], v5, s[44:47], s56 offen offset:2048 sc1
	s_waitcnt lgkmcnt(6)
	v_mfma_f32_32x32x16_bf16 v[64:79], a[108:111], a[56:59], v[64:79]
	ds_read_b64_tr_b16 a[96:97], v15 offset:64
	ds_read_b64_tr_b16 a[98:99], v15 offset:1600
	s_waitcnt vmcnt(19)
	v_mfma_f32_32x32x16_bf16 v[48:63], a[112:115], a[60:63], v[48:63]
	ds_read_b64_tr_b16 a[100:101], v15 offset:3072
	ds_read_b64_tr_b16 a[102:103], v15 offset:4608
	buffer_load_dwordx4 a[16:19], v5, s[44:47], s56 offen offset:3072 sc1
	s_add_u32 s56, s56, 4096
	s_waitcnt lgkmcnt(6)
	v_mfma_f32_32x32x16_bf16 v[64:79], a[116:119], a[60:63], v[64:79]
	ds_read_b64_tr_b16 a[104:105], v15 offset:3136
	ds_read_b64_tr_b16 a[106:107], v15 offset:4672
	v_mfma_f32_32x32x16_bf16 v[80:95], a[120:123], a[28:31], v[80:95]
	ds_read_b64_tr_b16 a[108:109], v14 offset:24704
	ds_read_b64_tr_b16 a[110:111], v14 offset:26240
	s_waitcnt vmcnt(19) lgkmcnt(6)
	v_mfma_f32_32x32x16_bf16 v[48:63], a[92:95], a[64:67], v[48:63]
	ds_read_b64_tr_b16 a[112:113], v15 offset:6144
	ds_read_b64_tr_b16 a[114:115], v15 offset:7680
	buffer_load_dwordx4 a[20:23], v5, s[44:47], s56 offen offset:0 sc1
	v_mfma_f32_32x32x16_bf16 v[64:79], a[96:99], a[64:67], v[64:79]
	ds_read_b64_tr_b16 a[116:117], v15 offset:6208
	ds_read_b64_tr_b16 a[118:119], v15 offset:7744
	s_waitcnt vmcnt(18) lgkmcnt(6)
	v_mfma_f32_32x32x16_bf16 v[48:63], a[100:103], a[68:71], v[48:63]
	ds_read_b64_tr_b16 a[120:121], v15 offset:9216
	ds_read_b64_tr_b16 a[122:123], v15 offset:10752
	buffer_load_dwordx4 a[24:27], v5, s[44:47], s56 offen offset:1024 sc1
	v_mfma_f32_32x32x16_bf16 v[64:79], a[104:107], a[68:71], v[64:79]
	ds_read_b64_tr_b16 a[92:93], v15 offset:9280
	ds_read_b64_tr_b16 a[94:95], v15 offset:10816
	s_waitcnt lgkmcnt(6)
	v_mfma_f32_32x32x16_bf16 v[80:95], a[108:111], a[32:35], v[80:95]
	ds_read_b64_tr_b16 a[96:97], v14 offset:27776
	ds_read_b64_tr_b16 a[98:99], v14 offset:29312
	s_waitcnt vmcnt(17)
	v_mfma_f32_32x32x16_bf16 v[48:63], a[112:115], a[72:75], v[48:63]
	ds_read_b64_tr_b16 a[100:101], v15 offset:12288
	ds_read_b64_tr_b16 a[102:103], v15 offset:13824
	buffer_load_dwordx4 a[28:31], v5, s[44:47], s56 offen offset:2048 sc1
	s_waitcnt lgkmcnt(6)
	v_mfma_f32_32x32x16_bf16 v[64:79], a[116:119], a[72:75], v[64:79]
	ds_read_b64_tr_b16 a[104:105], v15 offset:12352
	ds_read_b64_tr_b16 a[106:107], v15 offset:13888
	s_waitcnt vmcnt(16)
	v_mfma_f32_32x32x16_bf16 v[48:63], a[120:123], a[76:79], v[48:63]
	ds_read_b64_tr_b16 a[108:109], v15 offset:15360
	ds_read_b64_tr_b16 a[110:111], v15 offset:16896
	buffer_load_dwordx4 a[32:35], v5, s[44:47], s56 offen offset:3072 sc1
	s_add_u32 s56, s56, 4096
	s_waitcnt lgkmcnt(6)
	v_mfma_f32_32x32x16_bf16 v[64:79], a[92:95], a[76:79], v[64:79]
	ds_read_b64_tr_b16 a[112:113], v15 offset:15424
	ds_read_b64_tr_b16 a[114:115], v15 offset:16960
	s_barrier
	v_mfma_f32_32x32x16_bf16 v[80:95], a[96:99], a[36:39], v[80:95]
	ds_read_b64_tr_b16 a[116:117], v15 offset:18432
	ds_read_b64_tr_b16 a[118:119], v15 offset:19968
	s_waitcnt vmcnt(15) lgkmcnt(6)
	v_mfma_f32_32x32x16_bf16 v[48:63], a[100:103], a[80:83], v[48:63]
	ds_read_b64_tr_b16 a[120:121], v15 offset:18496
	ds_read_b64_tr_b16 a[122:123], v15 offset:20032
	ds_read_b128 v[112:115], v19 offset:0
	ds_read_b128 v[116:119], v19 offset:1024
	v_mfma_f32_32x32x16_bf16 v[64:79], a[104:107], a[80:83], v[64:79]
	ds_read_b64_tr_b16 a[92:93], v15 offset:21504
	ds_read_b64_tr_b16 a[94:95], v15 offset:23040
	ds_read_b128 v[120:123], v19 offset:32768
	ds_read_b128 v[124:127], v19 offset:33792
	s_waitcnt vmcnt(13) lgkmcnt(10)
	v_mfma_f32_32x32x16_bf16 v[48:63], a[108:111], a[84:87], v[48:63]
	ds_read_b64_tr_b16 a[96:97], v15 offset:21568
	ds_read_b64_tr_b16 a[98:99], v15 offset:23104
	s_waitcnt lgkmcnt(6)
	v_add_f32 v112, v112, v116
	v_add_f32 v113, v113, v117
	v_add_f32 v114, v114, v118
	v_mfma_f32_32x32x16_bf16 v[64:79], a[112:115], a[84:87], v[64:79]
	ds_read_b64_tr_b16 a[100:101], v15 offset:24576
	ds_read_b64_tr_b16 a[102:103], v15 offset:26112
	s_waitcnt lgkmcnt(5)
	v_add_f32 v112, v112, v120
	v_add_f32 v113, v113, v121
	v_add_f32 v114, v114, v122
	s_waitcnt vmcnt(11)
	v_mfma_f32_32x32x16_bf16 v[48:63], a[116:119], a[88:91], v[48:63]
	ds_read_b64_tr_b16 a[104:105], v15 offset:24640
	ds_read_b64_tr_b16 a[106:107], v15 offset:26176
	s_waitcnt lgkmcnt(6)
	v_add_f32 v112, v112, v124
	v_add_f32 v113, v113, v125
	v_add_f32 v114, v114, v126
	v_mfma_f32_32x32x16_bf16 v[64:79], a[120:123], a[88:91], v[64:79]
	ds_read_b64_tr_b16 a[108:109], v15 offset:27648
	ds_read_b64_tr_b16 a[110:111], v15 offset:29184
	v_cvt_pk_bf16_f32 v3, v112, v112
	v_and_b32 v3, 0xffff0000, v3
	v_sub_f32 v20, v112, v3
	s_waitcnt vmcnt(9) lgkmcnt(6)
	v_mfma_f32_32x32x16_bf16 v[48:63], a[92:95], a[0:3], v[48:63]
	ds_read_b64_tr_b16 a[112:113], v15 offset:27712
	ds_read_b64_tr_b16 a[114:115], v15 offset:29248
	v_cvt_pk_bf16_f32 v20, v3, v20
	v_mov_b32 v21, v20
	v_mov_b32 v23, 0
	v_mfma_f32_32x32x16_bf16 v[64:79], a[96:99], a[0:3], v[64:79]
	ds_read_b64_tr_b16 a[116:117], v15 offset:30720
	ds_read_b64_tr_b16 a[118:119], v15 offset:32256
	v_cvt_pk_bf16_f32 v3, v113, v113
	v_and_b32 v3, 0xffff0000, v3
	v_sub_f32 v24, v113, v3
	s_waitcnt vmcnt(7) lgkmcnt(6)
	v_mfma_f32_32x32x16_bf16 v[48:63], a[100:103], a[4:7], v[48:63]
	ds_read_b64_tr_b16 a[120:121], v15 offset:30784
	ds_read_b64_tr_b16 a[122:123], v15 offset:32320
	v_cvt_pk_bf16_f32 v24, v3, v24
	v_mov_b32 v25, v24
	v_mov_b32 v27, 0
	v_mfma_f32_32x32x16_bf16 v[64:79], a[104:107], a[4:7], v[64:79]
	ds_read_b64_tr_b16 a[92:93], v15 offset:33792
	ds_read_b64_tr_b16 a[94:95], v15 offset:35328
	v_cvt_pk_bf16_f32 v3, v114, v114
	v_and_b32 v3, 0xffff0000, v3
	v_sub_f32 v28, v114, v3
	s_waitcnt vmcnt(6) lgkmcnt(6)
	v_mfma_f32_32x32x16_bf16 v[48:63], a[108:111], a[8:11], v[48:63]
	ds_read_b64_tr_b16 a[96:97], v15 offset:33856
	ds_read_b64_tr_b16 a[98:99], v15 offset:35392
	v_cvt_pk_bf16_f32 v28, v3, v28
	v_mov_b32 v29, v28
	v_mov_b32 v31, 0
	v_mfma_f32_32x32x16_bf16 v[64:79], a[112:115], a[8:11], v[64:79]
	ds_read_b64_tr_b16 a[100:101], v15 offset:36864
	ds_read_b64_tr_b16 a[102:103], v15 offset:38400
	v_add_f32 v96, v96, v98
	v_add_f32 v97, v97, v99
	v_add_f32 v96, v96, v100
	s_waitcnt vmcnt(5) lgkmcnt(6)
	v_mfma_f32_32x32x16_bf16 v[48:63], a[116:119], a[12:15], v[48:63]
	ds_read_b64_tr_b16 a[104:105], v15 offset:36928
	ds_read_b64_tr_b16 a[106:107], v15 offset:38464
	v_add_f32 v97, v97, v101
	v_add_f32 v96, v96, v102
	v_add_f32 v97, v97, v103
	v_mfma_f32_32x32x16_bf16 v[64:79], a[120:123], a[12:15], v[64:79]
	ds_read_b64_tr_b16 a[108:109], v15 offset:39936
	ds_read_b64_tr_b16 a[110:111], v15 offset:41472
	v_add_f32 v96, v96, v104
	v_add_f32 v97, v97, v105
	v_add_f32 v96, v96, v106
	s_waitcnt vmcnt(4) lgkmcnt(6)
	v_mfma_f32_32x32x16_bf16 v[48:63], a[92:95], a[16:19], v[48:63]
	ds_read_b64_tr_b16 a[112:113], v15 offset:40000
	ds_read_b64_tr_b16 a[114:115], v15 offset:41536
	v_add_f32 v97, v97, v107
	v_add_f32 v96, v96, v108
	v_add_f32 v97, v97, v109
	v_mfma_f32_32x32x16_bf16 v[64:79], a[96:99], a[16:19], v[64:79]
	ds_read_b64_tr_b16 a[116:117], v15 offset:43008
	ds_read_b64_tr_b16 a[118:119], v15 offset:44544
	v_add_f32 v96, v96, v110
	v_add_f32 v97, v97, v111
	v_mov_b32 v98, v96
	s_waitcnt vmcnt(3) lgkmcnt(6)
	v_mfma_f32_32x32x16_bf16 v[48:63], a[100:103], a[20:23], v[48:63]
	ds_read_b64_tr_b16 a[120:121], v15 offset:43072
	ds_read_b64_tr_b16 a[122:123], v15 offset:44608
	v_mov_b32 v99, v97
	v_mov_b32 v35, 0
	v_cmp_lt_u32 vcc, 31, v0
	v_mfma_f32_32x32x16_bf16 v[64:79], a[104:107], a[20:23], v[64:79]
	ds_read_b64_tr_b16 a[92:93], v15 offset:46080
	ds_read_b64_tr_b16 a[94:95], v15 offset:47616
	v_permlane32_swap_b32 v96, v98
	v_permlane32_swap_b32 v97, v99
	v_add_f32 v96, v96, v98
	s_waitcnt vmcnt(2) lgkmcnt(6)
	v_mfma_f32_32x32x16_bf16 v[48:63], a[108:111], a[24:27], v[48:63]
	ds_read_b64_tr_b16 a[96:97], v15 offset:46144
	ds_read_b64_tr_b16 a[98:99], v15 offset:47680
	v_add_f32 v97, v97, v99
	v_mul_f32 v96, 0x3b000000, v96
	v_mul_f32 v97, 0x3b000000, v97
	v_fma_f32 v97, -v96, v96, v97
	v_mfma_f32_32x32x16_bf16 v[64:79], a[112:115], a[24:27], v[64:79]
	ds_read_b64_tr_b16 a[100:101], v14 offset:30848
	ds_read_b64_tr_b16 a[102:103], v14 offset:32384
	v_max_f32 v97, 0, v97
	v_add_f32 v97, 0x3727c5ac, v97
	v_rsq_f32 v100, v97
	v_cvt_pk_bf16_f32 v32, -v96, -v96
	s_waitcnt vmcnt(1) lgkmcnt(6)
	v_mfma_f32_32x32x16_bf16 v[48:63], a[116:119], a[28:31], v[48:63]
	ds_read_b64_tr_b16 a[104:105], v14 offset:33920
	ds_read_b64_tr_b16 a[106:107], v14 offset:35456
	v_mul_f32 v38, v97, v100
	v_and_b32 v3, 0xffff0000, v32
	v_sub_f32_e64 v3, -v96, v3
	v_cvt_pk_bf16_f32 v33, v3, v3
	v_mfma_f32_32x32x16_bf16 v[64:79], a[120:123], a[28:31], v[64:79]
	ds_read_b64_tr_b16 a[108:109], v14 offset:36992
	ds_read_b64_tr_b16 a[110:111], v14 offset:38528
	v_cvt_pk_bf16_f32 v3, v38, v38
	v_and_b32 v3, 0xffff0000, v3
	v_sub_f32 v4, v38, v3
	v_cndmask_b32 v3, v3, v4, vcc
	s_waitcnt vmcnt(0) lgkmcnt(6)
	v_mfma_f32_32x32x16_bf16 v[48:63], a[92:95], a[32:35], v[48:63]
	ds_read_b64_tr_b16 a[112:113], v14 offset:40064
	ds_read_b64_tr_b16 a[114:115], v14 offset:41600
	v_cvt_pk_bf16_f32 v34, v3, v35
	v_mul_f32 v36, 0xc0135761, v100
	v_mul_f32 v37, v100, v100
	v_mul_f32 v37, v37, v100
	v_mfma_f32_32x32x16_bf16 v[64:79], a[96:99], a[32:35], v[64:79]
	ds_read_b64_tr_b16 a[116:117], v14 offset:43136
	ds_read_b64_tr_b16 a[118:119], v14 offset:44672
	v_mul_f32 v37, 0xbdd2d3e8, v37
	v_mfma_f32_32x32x16_bf16 v[48:63], v[20:23], v[32:35], v[48:63]
	v_mfma_f32_32x32x16_bf16 v[64:79], v[24:27], v[32:35], v[64:79]
	v_mfma_f32_32x32x16_bf16 v[80:95], v[28:31], v[32:35], v[80:95]
	s_nop 9
	v_pk_mul_f32 v[120:121], v[48:49], v[48:49]
	v_pk_mul_f32 v[122:123], v[50:51], v[50:51]
	v_pk_fma_f32 v[120:121], v[120:121], v[36:37], v[36:37] op_sel:[0,1,0] op_sel_hi:[1,1,0]
	v_pk_fma_f32 v[122:123], v[122:123], v[36:37], v[36:37] op_sel:[0,1,0] op_sel_hi:[1,1,0]
	v_pk_mul_f32 v[120:121], v[120:121], v[48:49]
	v_pk_mul_f32 v[122:123], v[122:123], v[50:51]
	v_exp_f32 v120, v120
	v_exp_f32 v121, v121
	v_exp_f32 v122, v122
	v_exp_f32 v123, v123
	v_pk_fma_f32 v[120:121], v[120:121], v[38:39], v[38:39] op_sel_hi:[1,0,0]
	v_pk_fma_f32 v[122:123], v[122:123], v[38:39], v[38:39] op_sel_hi:[1,0,0]
	v_rcp_f32 v120, v120
	v_rcp_f32 v121, v121
	v_rcp_f32 v122, v122
	v_rcp_f32 v123, v123
	v_pk_mul_f32 v[120:121], v[48:49], v[120:121]
	v_pk_mul_f32 v[122:123], v[50:51], v[122:123]
	v_cvt_pk_bf16_f32 v96, v120, v121
	v_cvt_pk_bf16_f32 v97, v122, v123
	v_pk_mul_f32 v[120:121], v[52:53], v[52:53]
	v_pk_mul_f32 v[122:123], v[54:55], v[54:55]
	v_pk_fma_f32 v[120:121], v[120:121], v[36:37], v[36:37] op_sel:[0,1,0] op_sel_hi:[1,1,0]
	v_pk_fma_f32 v[122:123], v[122:123], v[36:37], v[36:37] op_sel:[0,1,0] op_sel_hi:[1,1,0]
	v_pk_mul_f32 v[120:121], v[120:121], v[52:53]
	v_pk_mul_f32 v[122:123], v[122:123], v[54:55]
	v_exp_f32 v120, v120
	v_exp_f32 v121, v121
	v_exp_f32 v122, v122
	v_exp_f32 v123, v123
	v_pk_fma_f32 v[120:121], v[120:121], v[38:39], v[38:39] op_sel_hi:[1,0,0]
	v_pk_fma_f32 v[122:123], v[122:123], v[38:39], v[38:39] op_sel_hi:[1,0,0]
	v_rcp_f32 v120, v120
	v_rcp_f32 v121, v121
	v_rcp_f32 v122, v122
	v_rcp_f32 v123, v123
	v_pk_mul_f32 v[120:121], v[52:53], v[120:121]
	v_pk_mul_f32 v[122:123], v[54:55], v[122:123]
	v_cvt_pk_bf16_f32 v98, v120, v121
	v_cvt_pk_bf16_f32 v99, v122, v123
	buffer_store_dwordx4 v[96:99], v5, s[44:47], s58 offen offset:0 sc1
	v_pk_mul_f32 v[120:121], v[56:57], v[56:57]
	v_pk_mul_f32 v[122:123], v[58:59], v[58:59]
	v_pk_fma_f32 v[120:121], v[120:121], v[36:37], v[36:37] op_sel:[0,1,0] op_sel_hi:[1,1,0]
	v_pk_fma_f32 v[122:123], v[122:123], v[36:37], v[36:37] op_sel:[0,1,0] op_sel_hi:[1,1,0]
	v_pk_mul_f32 v[120:121], v[120:121], v[56:57]
	v_pk_mul_f32 v[122:123], v[122:123], v[58:59]
	v_exp_f32 v120, v120
	v_exp_f32 v121, v121
	v_exp_f32 v122, v122
	v_exp_f32 v123, v123
	v_pk_fma_f32 v[120:121], v[120:121], v[38:39], v[38:39] op_sel_hi:[1,0,0]
	v_pk_fma_f32 v[122:123], v[122:123], v[38:39], v[38:39] op_sel_hi:[1,0,0]
	v_rcp_f32 v120, v120
	v_rcp_f32 v121, v121
	v_rcp_f32 v122, v122
	v_rcp_f32 v123, v123
	v_pk_mul_f32 v[120:121], v[56:57], v[120:121]
	v_pk_mul_f32 v[122:123], v[58:59], v[122:123]
	v_cvt_pk_bf16_f32 v100, v120, v121
	v_cvt_pk_bf16_f32 v101, v122, v123
	v_pk_mul_f32 v[120:121], v[60:61], v[60:61]
	v_pk_mul_f32 v[122:123], v[62:63], v[62:63]
	v_pk_fma_f32 v[120:121], v[120:121], v[36:37], v[36:37] op_sel:[0,1,0] op_sel_hi:[1,1,0]
	v_pk_fma_f32 v[122:123], v[122:123], v[36:37], v[36:37] op_sel:[0,1,0] op_sel_hi:[1,1,0]
	v_pk_mul_f32 v[120:121], v[120:121], v[60:61]
	v_pk_mul_f32 v[122:123], v[122:123], v[62:63]
	v_exp_f32 v120, v120
	v_exp_f32 v121, v121
	v_exp_f32 v122, v122
	v_exp_f32 v123, v123
	v_pk_fma_f32 v[120:121], v[120:121], v[38:39], v[38:39] op_sel_hi:[1,0,0]
	v_pk_fma_f32 v[122:123], v[122:123], v[38:39], v[38:39] op_sel_hi:[1,0,0]
	v_rcp_f32 v120, v120
	v_rcp_f32 v121, v121
	v_rcp_f32 v122, v122
	v_rcp_f32 v123, v123
	v_pk_mul_f32 v[120:121], v[60:61], v[120:121]
	v_pk_mul_f32 v[122:123], v[62:63], v[122:123]
	v_cvt_pk_bf16_f32 v102, v120, v121
	v_cvt_pk_bf16_f32 v103, v122, v123
	buffer_store_dwordx4 v[100:103], v5, s[44:47], s58 offen offset:1024 sc1
	s_add_u32 s58, s58, 16384
	v_pk_mul_f32 v[120:121], v[64:65], v[64:65]
	v_pk_mul_f32 v[122:123], v[66:67], v[66:67]
	v_pk_fma_f32 v[120:121], v[120:121], v[36:37], v[36:37] op_sel:[0,1,0] op_sel_hi:[1,1,0]
	v_pk_fma_f32 v[122:123], v[122:123], v[36:37], v[36:37] op_sel:[0,1,0] op_sel_hi:[1,1,0]
	v_pk_mul_f32 v[120:121], v[120:121], v[64:65]
	v_pk_mul_f32 v[122:123], v[122:123], v[66:67]
	v_exp_f32 v120, v120
	v_exp_f32 v121, v121
	v_exp_f32 v122, v122
	v_exp_f32 v123, v123
	v_pk_fma_f32 v[120:121], v[120:121], v[38:39], v[38:39] op_sel_hi:[1,0,0]
	v_pk_fma_f32 v[122:123], v[122:123], v[38:39], v[38:39] op_sel_hi:[1,0,0]
	v_rcp_f32 v120, v120
	v_rcp_f32 v121, v121
	v_rcp_f32 v122, v122
	v_rcp_f32 v123, v123
	v_pk_mul_f32 v[120:121], v[64:65], v[120:121]
	v_pk_mul_f32 v[122:123], v[66:67], v[122:123]
	v_cvt_pk_bf16_f32 v104, v120, v121
	v_cvt_pk_bf16_f32 v105, v122, v123
	v_pk_mul_f32 v[120:121], v[68:69], v[68:69]
	v_pk_mul_f32 v[122:123], v[70:71], v[70:71]
	v_pk_fma_f32 v[120:121], v[120:121], v[36:37], v[36:37] op_sel:[0,1,0] op_sel_hi:[1,1,0]
	v_pk_fma_f32 v[122:123], v[122:123], v[36:37], v[36:37] op_sel:[0,1,0] op_sel_hi:[1,1,0]
	v_pk_mul_f32 v[120:121], v[120:121], v[68:69]
	v_pk_mul_f32 v[122:123], v[122:123], v[70:71]
	v_exp_f32 v120, v120
	v_exp_f32 v121, v121
	v_exp_f32 v122, v122
	v_exp_f32 v123, v123
	v_pk_fma_f32 v[120:121], v[120:121], v[38:39], v[38:39] op_sel_hi:[1,0,0]
	v_pk_fma_f32 v[122:123], v[122:123], v[38:39], v[38:39] op_sel_hi:[1,0,0]
	v_rcp_f32 v120, v120
	v_rcp_f32 v121, v121
	v_rcp_f32 v122, v122
	v_rcp_f32 v123, v123
	v_pk_mul_f32 v[120:121], v[68:69], v[120:121]
	v_pk_mul_f32 v[122:123], v[70:71], v[122:123]
	v_cvt_pk_bf16_f32 v106, v120, v121
	v_cvt_pk_bf16_f32 v107, v122, v123
	buffer_store_dwordx4 v[104:107], v5, s[44:47], s58 offen offset:0 sc1
	v_pk_mul_f32 v[120:121], v[72:73], v[72:73]
	v_pk_mul_f32 v[122:123], v[74:75], v[74:75]
	v_pk_fma_f32 v[120:121], v[120:121], v[36:37], v[36:37] op_sel:[0,1,0] op_sel_hi:[1,1,0]
	v_pk_fma_f32 v[122:123], v[122:123], v[36:37], v[36:37] op_sel:[0,1,0] op_sel_hi:[1,1,0]
	v_pk_mul_f32 v[120:121], v[120:121], v[72:73]
	v_pk_mul_f32 v[122:123], v[122:123], v[74:75]
	v_exp_f32 v120, v120
	v_exp_f32 v121, v121
	v_exp_f32 v122, v122
	v_exp_f32 v123, v123
	v_pk_fma_f32 v[120:121], v[120:121], v[38:39], v[38:39] op_sel_hi:[1,0,0]
	v_pk_fma_f32 v[122:123], v[122:123], v[38:39], v[38:39] op_sel_hi:[1,0,0]
	v_rcp_f32 v120, v120
	v_rcp_f32 v121, v121
	v_rcp_f32 v122, v122
	v_rcp_f32 v123, v123
	v_pk_mul_f32 v[120:121], v[72:73], v[120:121]
	v_pk_mul_f32 v[122:123], v[74:75], v[122:123]
	v_cvt_pk_bf16_f32 v108, v120, v121
	v_cvt_pk_bf16_f32 v109, v122, v123
	v_pk_mul_f32 v[120:121], v[76:77], v[76:77]
	v_pk_mul_f32 v[122:123], v[78:79], v[78:79]
	v_pk_fma_f32 v[120:121], v[120:121], v[36:37], v[36:37] op_sel:[0,1,0] op_sel_hi:[1,1,0]
	v_pk_fma_f32 v[122:123], v[122:123], v[36:37], v[36:37] op_sel:[0,1,0] op_sel_hi:[1,1,0]
	v_pk_mul_f32 v[120:121], v[120:121], v[76:77]
	v_pk_mul_f32 v[122:123], v[122:123], v[78:79]
	v_exp_f32 v120, v120
	v_exp_f32 v121, v121
	v_exp_f32 v122, v122
	v_exp_f32 v123, v123
	v_pk_fma_f32 v[120:121], v[120:121], v[38:39], v[38:39] op_sel_hi:[1,0,0]
	v_pk_fma_f32 v[122:123], v[122:123], v[38:39], v[38:39] op_sel_hi:[1,0,0]
	v_rcp_f32 v120, v120
	v_rcp_f32 v121, v121
	v_rcp_f32 v122, v122
	v_rcp_f32 v123, v123
	v_pk_mul_f32 v[120:121], v[76:77], v[120:121]
	v_pk_mul_f32 v[122:123], v[78:79], v[122:123]
	v_cvt_pk_bf16_f32 v110, v120, v121
	v_cvt_pk_bf16_f32 v111, v122, v123
	buffer_store_dwordx4 v[108:111], v5, s[44:47], s58 offen offset:1024 sc1
	s_add_u32 s58, s58, 16384
	s_add_u32 s58, s58, s64
	s_waitcnt lgkmcnt(6)
	v_mfma_f32_32x32x16_bf16 v[80:95], a[100:103], a[40:43], v[80:95]
	ds_read_b64_tr_b16 a[120:121], v14 offset:46208
	ds_read_b64_tr_b16 a[122:123], v14 offset:47744
	v_mfma_f32_32x32x16_bf16 v[80:95], a[104:107], a[44:47], v[80:95]
	ds_read_b64_tr_b16 a[92:93], v15 offset:128
	ds_read_b64_tr_b16 a[94:95], v15 offset:1664
	s_waitcnt lgkmcnt(6)
	v_mfma_f32_32x32x16_bf16 v[80:95], a[108:111], a[48:51], v[80:95]
	ds_read_b64_tr_b16 a[96:97], v15 offset:3200
	ds_read_b64_tr_b16 a[98:99], v15 offset:4736
	v_mfma_f32_32x32x16_bf16 v[80:95], a[112:115], a[52:55], v[80:95]
	ds_read_b64_tr_b16 a[100:101], v15 offset:6272
	ds_read_b64_tr_b16 a[102:103], v15 offset:7808
	s_waitcnt lgkmcnt(6)
	v_mfma_f32_32x32x16_bf16 v[80:95], a[116:119], a[56:59], v[80:95]
	ds_read_b64_tr_b16 a[104:105], v15 offset:9344
	ds_read_b64_tr_b16 a[106:107], v15 offset:10880
	v_mfma_f32_32x32x16_bf16 v[80:95], a[120:123], a[60:63], v[80:95]
	ds_read_b64_tr_b16 a[108:109], v15 offset:12416
	ds_read_b64_tr_b16 a[110:111], v15 offset:13952
	s_waitcnt vmcnt(2)
	s_atomic_add s66, s[68:69], 0
	s_waitcnt lgkmcnt(6)
	v_mfma_f32_32x32x16_bf16 v[80:95], a[92:95], a[64:67], v[80:95]
	ds_read_b64_tr_b16 a[112:113], v15 offset:15488
	ds_read_b64_tr_b16 a[114:115], v15 offset:17024
	v_mfma_f32_32x32x16_bf16 v[80:95], a[96:99], a[68:71], v[80:95]
	ds_read_b64_tr_b16 a[116:117], v15 offset:18560
	ds_read_b64_tr_b16 a[118:119], v15 offset:20096
	s_waitcnt lgkmcnt(6)
	v_mfma_f32_32x32x16_bf16 v[80:95], a[100:103], a[72:75], v[80:95]
	ds_read_b64_tr_b16 a[120:121], v15 offset:21632
	ds_read_b64_tr_b16 a[122:123], v15 offset:23168
	v_mfma_f32_32x32x16_bf16 v[80:95], a[104:107], a[76:79], v[80:95]
	ds_read_b64_tr_b16 a[92:93], v15 offset:24704
	ds_read_b64_tr_b16 a[94:95], v15 offset:26240
	ds_read_b64_tr_b16 a[40:41], v16 offset:0
	s_waitcnt lgkmcnt(7)
	v_mfma_f32_32x32x16_bf16 v[80:95], a[108:111], a[80:83], v[80:95]
	ds_read_b64_tr_b16 a[96:97], v15 offset:27776
	ds_read_b64_tr_b16 a[98:99], v15 offset:29312
	ds_read_b64_tr_b16 a[42:43], v16 offset:1024
	v_mfma_f32_32x32x16_bf16 v[80:95], a[112:115], a[84:87], v[80:95]
	ds_read_b64_tr_b16 a[100:101], v15 offset:30848
	ds_read_b64_tr_b16 a[102:103], v15 offset:32384
	ds_read_b64_tr_b16 a[44:45], v17 offset:0
	s_waitcnt lgkmcnt(9)
	v_mfma_f32_32x32x16_bf16 v[80:95], a[116:119], a[88:91], v[80:95]
	ds_read_b64_tr_b16 a[104:105], v15 offset:33920
	ds_read_b64_tr_b16 a[106:107], v15 offset:35456
	ds_read_b64_tr_b16 a[46:47], v17 offset:1024
	v_mfma_f32_32x32x16_bf16 v[80:95], a[120:123], a[0:3], v[80:95]
	ds_read_b64_tr_b16 a[108:109], v15 offset:36992
	ds_read_b64_tr_b16 a[110:111], v15 offset:38528
	ds_read_b64_tr_b16 a[48:49], v16 offset:2048
	s_waitcnt lgkmcnt(10)
	v_mfma_f32_32x32x16_bf16 v[80:95], a[92:95], a[4:7], v[80:95]
	ds_read_b64_tr_b16 a[112:113], v15 offset:40064
	ds_read_b64_tr_b16 a[114:115], v15 offset:41600
	ds_read_b64_tr_b16 a[50:51], v16 offset:3072
	v_mfma_f32_32x32x16_bf16 v[80:95], a[96:99], a[8:11], v[80:95]
	ds_read_b64_tr_b16 a[116:117], v15 offset:43136
	ds_read_b64_tr_b16 a[118:119], v15 offset:44672
	ds_read_b64_tr_b16 a[52:53], v17 offset:2048
	s_waitcnt lgkmcnt(10)
	v_mfma_f32_32x32x16_bf16 v[80:95], a[100:103], a[12:15], v[80:95]
	ds_read_b64_tr_b16 a[120:121], v15 offset:46208
	ds_read_b64_tr_b16 a[122:123], v15 offset:47744
	ds_read_b64_tr_b16 a[54:55], v17 offset:3072
	v_mfma_f32_32x32x16_bf16 v[80:95], a[104:107], a[16:19], v[80:95]
	ds_read_b64_tr_b16 a[56:57], v16 offset:4096
	ds_read_b64_tr_b16 a[58:59], v16 offset:5120
	s_waitcnt lgkmcnt(9)
	v_mfma_f32_32x32x16_bf16 v[80:95], a[108:111], a[20:23], v[80:95]
	ds_read_b64_tr_b16 a[60:61], v17 offset:4096
	ds_read_b64_tr_b16 a[62:63], v17 offset:5120
	v_mfma_f32_32x32x16_bf16 v[80:95], a[112:115], a[24:27], v[80:95]
	ds_read_b64_tr_b16 a[64:65], v16 offset:6144
	ds_read_b64_tr_b16 a[66:67], v16 offset:7168
	s_waitcnt lgkmcnt(7)
	v_mfma_f32_32x32x16_bf16 v[80:95], a[116:119], a[28:31], v[80:95]
	ds_read_b64_tr_b16 a[68:69], v17 offset:6144
	ds_read_b64_tr_b16 a[70:71], v17 offset:7168
	v_mfma_f32_32x32x16_bf16 v[80:95], a[120:123], a[32:35], v[80:95]
	ds_read_b32 v2, v5
	s_waitcnt lgkmcnt(1)
	s_barrier
	s_cmp_lg_u32 s64, 0
	s_cbranch_scc1 L_no3_0
	s_nop 7
	v_pk_mul_f32 v[120:121], v[80:81], v[80:81]
	v_pk_mul_f32 v[122:123], v[82:83], v[82:83]
	v_pk_fma_f32 v[120:121], v[120:121], v[36:37], v[36:37] op_sel:[0,1,0] op_sel_hi:[1,1,0]
	v_pk_fma_f32 v[122:123], v[122:123], v[36:37], v[36:37] op_sel:[0,1,0] op_sel_hi:[1,1,0]
	v_pk_mul_f32 v[120:121], v[120:121], v[80:81]
	v_pk_mul_f32 v[122:123], v[122:123], v[82:83]
	v_exp_f32 v120, v120
	v_exp_f32 v121, v121
	v_exp_f32 v122, v122
	v_exp_f32 v123, v123
	v_pk_fma_f32 v[120:121], v[120:121], v[38:39], v[38:39] op_sel_hi:[1,0,0]
	v_pk_fma_f32 v[122:123], v[122:123], v[38:39], v[38:39] op_sel_hi:[1,0,0]
	v_rcp_f32 v120, v120
	v_rcp_f32 v121, v121
	v_rcp_f32 v122, v122
	v_rcp_f32 v123, v123
	v_pk_mul_f32 v[120:121], v[80:81], v[120:121]
	v_pk_mul_f32 v[122:123], v[82:83], v[122:123]
	v_cvt_pk_bf16_f32 v112, v120, v121
	v_cvt_pk_bf16_f32 v113, v122, v123
	v_pk_mul_f32 v[120:121], v[84:85], v[84:85]
	v_pk_mul_f32 v[122:123], v[86:87], v[86:87]
	v_pk_fma_f32 v[120:121], v[120:121], v[36:37], v[36:37] op_sel:[0,1,0] op_sel_hi:[1,1,0]
	v_pk_fma_f32 v[122:123], v[122:123], v[36:37], v[36:37] op_sel:[0,1,0] op_sel_hi:[1,1,0]
	v_pk_mul_f32 v[120:121], v[120:121], v[84:85]
	v_pk_mul_f32 v[122:123], v[122:123], v[86:87]
	v_exp_f32 v120, v120
	v_exp_f32 v121, v121
	v_exp_f32 v122, v122
	v_exp_f32 v123, v123
	v_pk_fma_f32 v[120:121], v[120:121], v[38:39], v[38:39] op_sel_hi:[1,0,0]
	v_pk_fma_f32 v[122:123], v[122:123], v[38:39], v[38:39] op_sel_hi:[1,0,0]
	v_rcp_f32 v120, v120
	v_rcp_f32 v121, v121
	v_rcp_f32 v122, v122
	v_rcp_f32 v123, v123
	v_pk_mul_f32 v[120:121], v[84:85], v[120:121]
	v_pk_mul_f32 v[122:123], v[86:87], v[122:123]
	v_cvt_pk_bf16_f32 v114, v120, v121
	v_cvt_pk_bf16_f32 v115, v122, v123
	s_nop 2
L_no3_0:
	buffer_store_dwordx4 v[112:115], v5, s[44:47], s58 offen offset:0 sc1
	s_mov_b32 s60, 0
	s_atomic_add s60, s[70:71], 0 glc
	s_waitcnt vmcnt(1)
	s_atomic_add s62, s[68:69], 0
	s_cmp_lg_u32 s64, 0
	s_cbranch_scc1 L_no3_1
	s_nop 0
	v_pk_mul_f32 v[120:121], v[88:89], v[88:89]
	v_pk_mul_f32 v[122:123], v[90:91], v[90:91]
	v_pk_fma_f32 v[120:121], v[120:121], v[36:37], v[36:37] op_sel:[0,1,0] op_sel_hi:[1,1,0]
	v_pk_fma_f32 v[122:123], v[122:123], v[36:37], v[36:37] op_sel:[0,1,0] op_sel_hi:[1,1,0]
	v_pk_mul_f32 v[120:121], v[120:121], v[88:89]
	v_pk_mul_f32 v[122:123], v[122:123], v[90:91]
	v_exp_f32 v120, v120
	v_exp_f32 v121, v121
	v_exp_f32 v122, v122
	v_exp_f32 v123, v123
	v_pk_fma_f32 v[120:121], v[120:121], v[38:39], v[38:39] op_sel_hi:[1,0,0]
	v_pk_fma_f32 v[122:123], v[122:123], v[38:39], v[38:39] op_sel_hi:[1,0,0]
	v_rcp_f32 v120, v120
	v_rcp_f32 v121, v121
	v_rcp_f32 v122, v122
	v_rcp_f32 v123, v123
	v_pk_mul_f32 v[120:121], v[88:89], v[120:121]
	v_pk_mul_f32 v[122:123], v[90:91], v[122:123]
	v_cvt_pk_bf16_f32 v116, v120, v121
	v_cvt_pk_bf16_f32 v117, v122, v123
	v_pk_mul_f32 v[120:121], v[92:93], v[92:93]
	v_pk_mul_f32 v[122:123], v[94:95], v[94:95]
	v_pk_fma_f32 v[120:121], v[120:121], v[36:37], v[36:37] op_sel:[0,1,0] op_sel_hi:[1,1,0]
	v_pk_fma_f32 v[122:123], v[122:123], v[36:37], v[36:37] op_sel:[0,1,0] op_sel_hi:[1,1,0]
	v_pk_mul_f32 v[120:121], v[120:121], v[92:93]
	v_pk_mul_f32 v[122:123], v[122:123], v[94:95]
	v_exp_f32 v120, v120
	v_exp_f32 v121, v121
	v_exp_f32 v122, v122
	v_exp_f32 v123, v123
	v_pk_fma_f32 v[120:121], v[120:121], v[38:39], v[38:39] op_sel_hi:[1,0,0]
	v_pk_fma_f32 v[122:123], v[122:123], v[38:39], v[38:39] op_sel_hi:[1,0,0]
	v_rcp_f32 v120, v120
	v_rcp_f32 v121, v121
	v_rcp_f32 v122, v122
	v_rcp_f32 v123, v123
	v_pk_mul_f32 v[120:121], v[92:93], v[120:121]
	v_pk_mul_f32 v[122:123], v[94:95], v[122:123]
	v_cvt_pk_bf16_f32 v118, v120, v121
	v_cvt_pk_bf16_f32 v119, v122, v123
	s_nop 2
L_no3_1:
	buffer_store_dwordx4 v[116:119], v5, s[44:47], s58 offen offset:1024 sc1
	s_add_u32 s58, s58, 16384
	s_mov_b32 s59, 0
	s_branch L_d0_chk
L_d0_poll:
	s_mov_b32 s60, 0
	s_atomic_add s60, s[70:71], 0 glc
L_d0_chk:
	s_add_u32 s59, s59, 1
	s_waitcnt lgkmcnt(0)
	s_bfe_u32 s60, s60, 524288
	s_cmp_ge_u32 s60, 8
	s_cbranch_scc1 L_d0_done
	s_cmp_lt_u32 s59, 262144
	s_cbranch_scc1 L_d0_poll
L_d0_done:
	buffer_load_dwordx4 a[24:27], v5, s[44:47], s67 offen offset:0 sc1
	s_mov_b32 s60, 0
	s_atomic_add s60, s[70:71], 0 glc
	buffer_load_dwordx4 a[28:31], v5, s[44:47], s67 offen offset:1024 sc1
	buffer_load_dwordx4 a[32:35], v5, s[44:47], s67 offen offset:2048 sc1
	buffer_load_dwordx4 a[36:39], v5, s[44:47], s67 offen offset:3072 sc1
	s_add_u32 s67, s67, 4096
	buffer_load_dwordx4 a[72:75], v5, s[44:47], s67 offen offset:0 sc1
	buffer_load_dwordx4 a[76:79], v5, s[44:47], s67 offen offset:1024 sc1
	buffer_load_dwordx4 a[80:83], v5, s[44:47], s67 offen offset:2048 sc1
	buffer_load_dwordx4 a[84:87], v5, s[44:47], s67 offen offset:3072 sc1
	s_add_u32 s67, s67, 4096
	v_lshlrev_b32 v48, 16, v6
	v_and_b32 v49, 0xffff0000, v6
	v_lshlrev_b32 v2, 16, v40
	v_and_b32 v3, 0xffff0000, v40
	v_add_f32 v48, v48, v2
	v_add_f32 v49, v49, v3
	v_lshlrev_b32 v50, 16, v7
	v_and_b32 v51, 0xffff0000, v7
	v_lshlrev_b32 v2, 16, v41
	v_and_b32 v3, 0xffff0000, v41
	v_add_f32 v50, v50, v2
	v_add_f32 v51, v51, v3
	v_lshlrev_b32 v52, 16, v8
	v_and_b32 v53, 0xffff0000, v8
	v_lshlrev_b32 v2, 16, v42
	v_and_b32 v3, 0xffff0000, v42
	v_add_f32 v52, v52, v2
	v_add_f32 v53, v53, v3
	v_lshlrev_b32 v54, 16, v9
	v_and_b32 v55, 0xffff0000, v9
	v_lshlrev_b32 v2, 16, v43
	v_and_b32 v3, 0xffff0000, v43
	v_add_f32 v54, v54, v2
	v_add_f32 v55, v55, v3
	v_lshlrev_b32 v56, 16, v10
	v_and_b32 v57, 0xffff0000, v10
	v_lshlrev_b32 v2, 16, v44
	v_and_b32 v3, 0xffff0000, v44
	v_add_f32 v56, v56, v2
	v_add_f32 v57, v57, v3
	v_lshlrev_b32 v58, 16, v11
	v_and_b32 v59, 0xffff0000, v11
	v_lshlrev_b32 v2, 16, v45
	v_and_b32 v3, 0xffff0000, v45
	v_add_f32 v58, v58, v2
	v_add_f32 v59, v59, v3
	v_lshlrev_b32 v60, 16, v12
	v_and_b32 v61, 0xffff0000, v12
	v_lshlrev_b32 v2, 16, v46
	v_and_b32 v3, 0xffff0000, v46
	v_add_f32 v60, v60, v2
	v_add_f32 v61, v61, v3
	v_lshlrev_b32 v62, 16, v13
	v_and_b32 v63, 0xffff0000, v13
	v_lshlrev_b32 v2, 16, v47
	v_and_b32 v3, 0xffff0000, v47
	v_add_f32 v62, v62, v2
	v_add_f32 v63, v63, v3
	s_lshl_b32 s50, s53, 14
	s_sub_u32 s50, s50, 98304
	v_add_u32 v14, s50, v16
	v_add_u32 v15, s50, v17
	v_and_b32 v2, 31, v0
	v_lshrrev_b32 v3, 5, v0
	v_and_b32 v4, 7, v0
	v_xor_b32 v3, v3, v4
	v_lshlrev_b32 v3, 4, v3
	v_lshl_add_u32 v3, v2, 8, v3
	s_lshl_b32 s50, s3, 13
	s_mul_i32 s51, s53, 16512
	s_add_u32 s50, s50, s51
	s_add_u32 s50, s50, 106496
	v_add_u32 v3, s50, v3
	v_xor_b32 v18, 0, v3
	v_xor_b32 v19, 32, v3
	v_xor_b32 v20, 64, v3
	v_xor_b32 v21, 96, v3
	v_xor_b32 v22, 128, v3
	v_xor_b32 v23, 160, v3
	v_xor_b32 v24, 192, v3
	v_xor_b32 v25, 224, v3
	v_lshrrev_b32 v2, 3, v0
	v_lshlrev_b32 v3, 1, v4
	v_xor_b32 v3, v3, v2
	v_lshlrev_b32 v3, 4, v3
	v_lshl_add_u32 v3, v2, 8, v3
	s_lshl_b32 s50, s3, 12
	s_add_u32 s50, s50, 106496
	v_add_u32 v26, s50, v3
	v_xor_b32 v27, 16, v26
	v_lshlrev_b32 v4, 4, v4
	v_lshl_add_u32 v28, v2, 10, v4
	s_lshl_b32 s56, s4, 16
	s_lshl_b32 s51, s3, 14
	s_add_u32 s56, s56, s51
	s_lshl_b32 s51, s5, 7
	s_add_u32 s56, s56, s51
	s_waitcnt vmcnt(8)
	s_waitcnt lgkmcnt(0)
	s_atomic_add s63, s[68:69], 0
	buffer_load_dwordx4 a[88:91], v5, s[44:47], s67 offen offset:0 sc1
	buffer_load_dwordx4 a[92:95], v5, s[44:47], s67 offen offset:1024 sc1
	buffer_load_dwordx4 a[96:99], v5, s[44:47], s67 offen offset:2048 sc1
	buffer_load_dwordx4 a[100:103], v5, s[44:47], s67 offen offset:3072 sc1
	s_add_u32 s67, s67, 4096
	buffer_load_dwordx4 a[104:107], v5, s[44:47], s67 offen offset:0 sc1
	s_bfe_u32 s51, s60, 0x80008
	s_cmp_ge_u32 s51, 8
	s_cbranch_scc1 L_d1ok
	s_mov_b32 s59, 0
L_d1_poll:
	s_mov_b32 s60, 0
	s_atomic_add s60, s[70:71], 0 glc
	s_add_u32 s59, s59, 1
	s_waitcnt lgkmcnt(0)
	s_bfe_u32 s60, s60, 524296
	s_cmp_ge_u32 s60, 8
	s_cbranch_scc1 L_d1_done
	s_cmp_lt_u32 s59, 262144
	s_cbranch_scc1 L_d1_poll
L_d1_done:
L_d1ok:
	s_waitcnt vmcnt(12)
	v_mfma_f32_32x32x16_bf16 v[48:63], a[40:43], a[24:27], v[48:63]
	buffer_load_dwordx4 a[108:111], v5, s[44:47], s67 offen offset:1024 sc1
	v_mfma_f32_32x32x16_bf16 v[64:79], a[44:47], a[24:27], 0
	s_waitcnt vmcnt(12)
	v_mfma_f32_32x32x16_bf16 v[48:63], a[48:51], a[28:31], v[48:63]
	buffer_load_dwordx4 a[112:115], v5, s[44:47], s67 offen offset:2048 sc1
	v_mfma_f32_32x32x16_bf16 v[64:79], a[52:55], a[28:31], v[64:79]
	s_waitcnt vmcnt(12)
	v_mfma_f32_32x32x16_bf16 v[48:63], a[56:59], a[32:35], v[48:63]
	ds_read_b64_tr_b16 a[8:9], v16 offset:8192
	ds_read_b64_tr_b16 a[10:11], v16 offset:9216
	buffer_load_dwordx4 a[116:119], v5, s[44:47], s67 offen offset:3072 sc1
	s_add_u32 s67, s67, 4096
	v_mfma_f32_32x32x16_bf16 v[64:79], a[60:63], a[32:35], v[64:79]
	ds_read_b64_tr_b16 a[12:13], v17 offset:8192
	ds_read_b64_tr_b16 a[14:15], v17 offset:9216
	s_waitcnt vmcnt(12)
	v_mfma_f32_32x32x16_bf16 v[48:63], a[64:67], a[36:39], v[48:63]
	ds_read_b64_tr_b16 a[16:17], v16 offset:10240
	ds_read_b64_tr_b16 a[18:19], v16 offset:11264
	buffer_load_dwordx4 a[120:123], v5, s[44:47], s67 offen offset:0 sc1
	v_mfma_f32_32x32x16_bf16 v[64:79], a[68:71], a[36:39], v[64:79]
	ds_read_b64_tr_b16 a[20:21], v17 offset:10240
	ds_read_b64_tr_b16 a[22:23], v17 offset:11264
	s_waitcnt vmcnt(12) lgkmcnt(4)
	v_mfma_f32_32x32x16_bf16 v[48:63], a[8:11], a[72:75], v[48:63]
	ds_read_b64_tr_b16 a[0:1], v16 offset:12288
	ds_read_b64_tr_b16 a[2:3], v16 offset:13312
	buffer_load_dwordx4 a[124:127], v5, s[44:47], s67 offen offset:1024 sc1
	v_mfma_f32_32x32x16_bf16 v[64:79], a[12:15], a[72:75], v[64:79]
	ds_read_b64_tr_b16 a[4:5], v17 offset:12288
	ds_read_b64_tr_b16 a[6:7], v17 offset:13312
	s_waitcnt vmcnt(12) lgkmcnt(4)
	v_mfma_f32_32x32x16_bf16 v[48:63], a[16:19], a[76:79], v[48:63]
	ds_read_b64_tr_b16 a[8:9], v16 offset:14336
	ds_read_b64_tr_b16 a[10:11], v16 offset:15360
	buffer_load_dwordx4 a[24:27], v5, s[44:47], s67 offen offset:2048 sc1
	v_mfma_f32_32x32x16_bf16 v[64:79], a[20:23], a[76:79], v[64:79]
	ds_read_b64_tr_b16 a[12:13], v17 offset:14336
	ds_read_b64_tr_b16 a[14:15], v17 offset:15360
	s_waitcnt vmcnt(12) lgkmcnt(4)
	v_mfma_f32_32x32x16_bf16 v[48:63], a[0:3], a[80:83], v[48:63]
	ds_read_b64_tr_b16 a[16:17], v16 offset:16384
	ds_read_b64_tr_b16 a[18:19], v16 offset:17408
	buffer_load_dwordx4 a[28:31], v5, s[44:47], s67 offen offset:3072 sc1
	s_add_u32 s67, s67, 4096
	v_mfma_f32_32x32x16_bf16 v[64:79], a[4:7], a[80:83], v[64:79]
	ds_read_b64_tr_b16 a[20:21], v17 offset:16384
	ds_read_b64_tr_b16 a[22:23], v17 offset:17408
	s_waitcnt vmcnt(12) lgkmcnt(4)
	v_mfma_f32_32x32x16_bf16 v[48:63], a[8:11], a[84:87], v[48:63]
	ds_read_b64_tr_b16 a[0:1], v16 offset:18432
	ds_read_b64_tr_b16 a[2:3], v16 offset:19456
	buffer_load_dwordx4 a[32:35], v5, s[44:47], s67 offen offset:0 sc1
	v_mfma_f32_32x32x16_bf16 v[64:79], a[12:15], a[84:87], v[64:79]
	ds_read_b64_tr_b16 a[4:5], v17 offset:18432
	ds_read_b64_tr_b16 a[6:7], v17 offset:19456
	s_waitcnt vmcnt(12) lgkmcnt(4)
	v_mfma_f32_32x32x16_bf16 v[48:63], a[16:19], a[88:91], v[48:63]
	ds_read_b64_tr_b16 a[8:9], v16 offset:20480
	ds_read_b64_tr_b16 a[10:11], v16 offset:21504
	buffer_load_dwordx4 a[36:39], v5, s[44:47], s67 offen offset:1024 sc1
	v_mfma_f32_32x32x16_bf16 v[64:79], a[20:23], a[88:91], v[64:79]
	ds_read_b64_tr_b16 a[12:13], v17 offset:20480
	ds_read_b64_tr_b16 a[14:15], v17 offset:21504
	s_waitcnt vmcnt(12) lgkmcnt(4)
	v_mfma_f32_32x32x16_bf16 v[48:63], a[0:3], a[92:95], v[48:63]
	ds_read_b64_tr_b16 a[16:17], v16 offset:22528
	ds_read_b64_tr_b16 a[18:19], v16 offset:23552
	buffer_load_dwordx4 a[72:75], v5, s[44:47], s67 offen offset:2048 sc1
	v_mfma_f32_32x32x16_bf16 v[64:79], a[4:7], a[92:95], v[64:79]
	ds_read_b64_tr_b16 a[20:21], v17 offset:22528
	ds_read_b64_tr_b16 a[22:23], v17 offset:23552
	s_waitcnt vmcnt(12) lgkmcnt(4)
	v_mfma_f32_32x32x16_bf16 v[48:63], a[8:11], a[96:99], v[48:63]
	ds_read_b64_tr_b16 a[0:1], v16 offset:24576
	ds_read_b64_tr_b16 a[2:3], v16 offset:25600
	buffer_load_dwordx4 a[76:79], v5, s[44:47], s67 offen offset:3072 sc1
	s_add_u32 s67, s67, 4096
	v_mfma_f32_32x32x16_bf16 v[64:79], a[12:15], a[96:99], v[64:79]
	ds_read_b64_tr_b16 a[4:5], v17 offset:24576
	ds_read_b64_tr_b16 a[6:7], v17 offset:25600
	s_waitcnt vmcnt(12) lgkmcnt(4)
	v_mfma_f32_32x32x16_bf16 v[48:63], a[16:19], a[100:103], v[48:63]
	ds_read_b64_tr_b16 a[8:9], v16 offset:26624
	ds_read_b64_tr_b16 a[10:11], v16 offset:27648
	buffer_load_dwordx4 a[80:83], v5, s[44:47], s67 offen offset:0 sc1
	v_mfma_f32_32x32x16_bf16 v[64:79], a[20:23], a[100:103], v[64:79]
	ds_read_b64_tr_b16 a[12:13], v17 offset:26624
	ds_read_b64_tr_b16 a[14:15], v17 offset:27648
	s_mov_b32 s61, 0
	s_atomic_umax s61, s[70:71], 0 glc
	s_barrier
	s_waitcnt vmcnt(12) lgkmcnt(4)
	v_mfma_f32_32x32x16_bf16 v[48:63], a[0:3], a[104:107], v[48:63]
	ds_read_b64_tr_b16 a[16:17], v16 offset:28672
	ds_read_b64_tr_b16 a[18:19], v16 offset:29696
	buffer_load_dwordx4 a[84:87], v5, s[44:47], s67 offen offset:1024 sc1
	v_mfma_f32_32x32x16_bf16 v[64:79], a[4:7], a[104:107], v[64:79]
	ds_read_b64_tr_b16 a[20:21], v17 offset:28672
	ds_read_b64_tr_b16 a[22:23], v17 offset:29696
	s_waitcnt vmcnt(12) lgkmcnt(4)
	v_mfma_f32_32x32x16_bf16 v[48:63], a[8:11], a[108:111], v[48:63]
	ds_read_b64_tr_b16 a[0:1], v16 offset:30720
	ds_read_b64_tr_b16 a[2:3], v16 offset:31744
	buffer_load_dwordx4 a[88:91], v5, s[44:47], s67 offen offset:2048 sc1
	v_mfma_f32_32x32x16_bf16 v[64:79], a[12:15], a[108:111], v[64:79]
	ds_read_b64_tr_b16 a[4:5], v17 offset:30720
	ds_read_b64_tr_b16 a[6:7], v17 offset:31744
	s_waitcnt vmcnt(12) lgkmcnt(4)
	v_mfma_f32_32x32x16_bf16 v[48:63], a[16:19], a[112:115], v[48:63]
	ds_read_b64_tr_b16 a[8:9], v16 offset:0
	ds_read_b64_tr_b16 a[10:11], v16 offset:1024
	buffer_load_dwordx4 a[92:95], v5, s[44:47], s67 offen offset:3072 sc1
	s_add_u32 s67, s67, 4096
	v_mfma_f32_32x32x16_bf16 v[64:79], a[20:23], a[112:115], v[64:79]
	ds_read_b64_tr_b16 a[12:13], v17 offset:0
	ds_read_b64_tr_b16 a[14:15], v17 offset:1024
	s_waitcnt vmcnt(12) lgkmcnt(4)
	v_mfma_f32_32x32x16_bf16 v[48:63], a[0:3], a[116:119], v[48:63]
	ds_read_b64_tr_b16 a[16:17], v16 offset:2048
	ds_read_b64_tr_b16 a[18:19], v16 offset:3072
	buffer_load_dwordx4 a[96:99], v5, s[44:47], s67 offen offset:0 sc1
	v_mfma_f32_32x32x16_bf16 v[64:79], a[4:7], a[116:119], v[64:79]
	ds_read_b64_tr_b16 a[20:21], v17 offset:2048
	ds_read_b64_tr_b16 a[22:23], v17 offset:3072
	s_waitcnt vmcnt(12) lgkmcnt(4)
	v_mfma_f32_32x32x16_bf16 v[48:63], a[8:11], a[120:123], v[48:63]
	ds_read_b64_tr_b16 a[0:1], v16 offset:4096
	ds_read_b64_tr_b16 a[2:3], v16 offset:5120
	buffer_load_dwordx4 a[100:103], v5, s[44:47], s67 offen offset:1024 sc1
	v_mfma_f32_32x32x16_bf16 v[64:79], a[12:15], a[120:123], v[64:79]
	ds_read_b64_tr_b16 a[4:5], v17 offset:4096
	ds_read_b64_tr_b16 a[6:7], v17 offset:5120
	s_waitcnt vmcnt(12) lgkmcnt(4)
	v_mfma_f32_32x32x16_bf16 v[48:63], a[16:19], a[124:127], v[48:63]
	ds_read_b64_tr_b16 a[8:9], v16 offset:6144
	ds_read_b64_tr_b16 a[10:11], v16 offset:7168
	buffer_load_dwordx4 a[104:107], v5, s[44:47], s67 offen offset:2048 sc1
	v_mfma_f32_32x32x16_bf16 v[64:79], a[20:23], a[124:127], v[64:79]
	ds_read_b64_tr_b16 a[12:13], v17 offset:6144
	ds_read_b64_tr_b16 a[14:15], v17 offset:7168
	s_waitcnt vmcnt(12) lgkmcnt(4)
	v_mfma_f32_32x32x16_bf16 v[48:63], a[0:3], a[24:27], v[48:63]
	ds_read_b64_tr_b16 a[16:17], v14 offset:0
	ds_read_b64_tr_b16 a[18:19], v14 offset:1024
	buffer_load_dwordx4 a[108:111], v5, s[44:47], s67 offen offset:3072 sc1
	s_add_u32 s67, s67, 4096
	v_mfma_f32_32x32x16_bf16 v[64:79], a[4:7], a[24:27], v[64:79]
	ds_read_b64_tr_b16 a[20:21], v15 offset:0
	ds_read_b64_tr_b16 a[22:23], v15 offset:1024
	s_waitcnt vmcnt(12) lgkmcnt(4)
	v_mfma_f32_32x32x16_bf16 v[48:63], a[8:11], a[28:31], v[48:63]
	ds_read_b64_tr_b16 a[0:1], v14 offset:2048
	ds_read_b64_tr_b16 a[2:3], v14 offset:3072
	v_mfma_f32_32x32x16_bf16 v[64:79], a[12:15], a[28:31], v[64:79]
	ds_read_b64_tr_b16 a[4:5], v15 offset:2048
	ds_read_b64_tr_b16 a[6:7], v15 offset:3072
	s_waitcnt vmcnt(11) lgkmcnt(4)
	v_mfma_f32_32x32x16_bf16 v[48:63], a[16:19], a[32:35], v[48:63]
	ds_read_b64_tr_b16 a[8:9], v14 offset:4096
	ds_read_b64_tr_b16 a[10:11], v14 offset:5120
	v_mfma_f32_32x32x16_bf16 v[64:79], a[20:23], a[32:35], v[64:79]
	ds_read_b64_tr_b16 a[12:13], v15 offset:4096
	ds_read_b64_tr_b16 a[14:15], v15 offset:5120
	s_cmp_ge_u32 s61, 0x80000
	s_cbranch_scc1 L_d2ok
	s_waitcnt lgkmcnt(0)
	s_cmp_ge_u32 s61, 0x80000
	s_cbranch_scc1 L_d2ok
	s_mov_b32 s59, 0
L_d2_poll:
	s_mov_b32 s60, 0
	s_atomic_add s60, s[70:71], 0 glc
	s_add_u32 s59, s59, 1
	s_waitcnt lgkmcnt(0)
	s_bfe_u32 s60, s60, 524304
	s_cmp_ge_u32 s60, 8
	s_cbranch_scc1 L_d2_done
	s_cmp_lt_u32 s59, 262144
	s_cbranch_scc1 L_d2_poll
L_d2_done:
L_d2ok:
	s_waitcnt vmcnt(10) lgkmcnt(4)
	v_mfma_f32_32x32x16_bf16 v[48:63], a[0:3], a[36:39], v[48:63]
	ds_read_b64_tr_b16 a[16:17], v14 offset:6144
	ds_read_b64_tr_b16 a[18:19], v14 offset:7168
	buffer_load_dwordx4 a[112:115], v5, s[44:47], s67 offen offset:0 sc1
	v_mfma_f32_32x32x16_bf16 v[64:79], a[4:7], a[36:39], v[64:79]
	ds_read_b64_tr_b16 a[20:21], v15 offset:6144
	ds_read_b64_tr_b16 a[22:23], v15 offset:7168
	buffer_load_dwordx4 a[116:119], v5, s[44:47], s67 offen offset:1024 sc1
	s_waitcnt vmcnt(11) lgkmcnt(4)
	v_mfma_f32_32x32x16_bf16 v[48:63], a[8:11], a[72:75], v[48:63]
	ds_read_b64_tr_b16 a[0:1], v14 offset:8192
	ds_read_b64_tr_b16 a[2:3], v14 offset:9216
	buffer_load_dwordx4 a[120:123], v5, s[44:47], s67 offen offset:2048 sc1
	v_mfma_f32_32x32x16_bf16 v[64:79], a[12:15], a[72:75], v[64:79]
	ds_read_b64_tr_b16 a[4:5], v15 offset:8192
	ds_read_b64_tr_b16 a[6:7], v15 offset:9216
	buffer_load_dwordx4 a[124:127], v5, s[44:47], s67 offen offset:3072 sc1
	s_add_u32 s67, s67, 4096
	s_waitcnt vmcnt(12) lgkmcnt(4)
	v_mfma_f32_32x32x16_bf16 v[48:63], a[16:19], a[76:79], v[48:63]
	ds_read_b64_tr_b16 a[8:9], v14 offset:10240
	ds_read_b64_tr_b16 a[10:11], v14 offset:11264
	buffer_load_dwordx4 a[24:27], v5, s[44:47], s67 offen offset:0 sc1
	v_mfma_f32_32x32x16_bf16 v[64:79], a[20:23], a[76:79], v[64:79]
	ds_read_b64_tr_b16 a[12:13], v15 offset:10240
	ds_read_b64_tr_b16 a[14:15], v15 offset:11264
	s_waitcnt vmcnt(12) lgkmcnt(4)
	v_mfma_f32_32x32x16_bf16 v[48:63], a[0:3], a[80:83], v[48:63]
	ds_read_b64_tr_b16 a[16:17], v14 offset:12288
	ds_read_b64_tr_b16 a[18:19], v14 offset:13312
	buffer_load_dwordx4 a[28:31], v5, s[44:47], s67 offen offset:1024 sc1
	v_mfma_f32_32x32x16_bf16 v[64:79], a[4:7], a[80:83], v[64:79]
	ds_read_b64_tr_b16 a[20:21], v15 offset:12288
	ds_read_b64_tr_b16 a[22:23], v15 offset:13312
	s_waitcnt vmcnt(12) lgkmcnt(4)
	v_mfma_f32_32x32x16_bf16 v[48:63], a[8:11], a[84:87], v[48:63]
	ds_read_b64_tr_b16 a[0:1], v14 offset:14336
	ds_read_b64_tr_b16 a[2:3], v14 offset:15360
	buffer_load_dwordx4 a[32:35], v5, s[44:47], s67 offen offset:2048 sc1
	v_mfma_f32_32x32x16_bf16 v[64:79], a[12:15], a[84:87], v[64:79]
	ds_read_b64_tr_b16 a[4:5], v15 offset:14336
	ds_read_b64_tr_b16 a[6:7], v15 offset:15360
	s_waitcnt vmcnt(12) lgkmcnt(4)
	v_mfma_f32_32x32x16_bf16 v[48:63], a[16:19], a[88:91], v[48:63]
	ds_read_b64_tr_b16 a[8:9], v14 offset:16384
	ds_read_b64_tr_b16 a[10:11], v14 offset:17408
	buffer_load_dwordx4 a[36:39], v5, s[44:47], s67 offen offset:3072 sc1
	s_add_u32 s67, s67, 4096
	v_mfma_f32_32x32x16_bf16 v[64:79], a[20:23], a[88:91], v[64:79]
	ds_read_b64_tr_b16 a[12:13], v15 offset:16384
	ds_read_b64_tr_b16 a[14:15], v15 offset:17408
	s_waitcnt vmcnt(12) lgkmcnt(4)
	v_mfma_f32_32x32x16_bf16 v[48:63], a[0:3], a[92:95], v[48:63]
	ds_read_b64_tr_b16 a[16:17], v14 offset:18432
	ds_read_b64_tr_b16 a[18:19], v14 offset:19456
	buffer_load_dwordx4 a[72:75], v5, s[44:47], s67 offen offset:0 sc1
	v_mfma_f32_32x32x16_bf16 v[64:79], a[4:7], a[92:95], v[64:79]
	ds_read_b64_tr_b16 a[20:21], v15 offset:18432
	ds_read_b64_tr_b16 a[22:23], v15 offset:19456
	s_waitcnt vmcnt(12) lgkmcnt(4)
	v_mfma_f32_32x32x16_bf16 v[48:63], a[8:11], a[96:99], v[48:63]
	ds_read_b64_tr_b16 a[0:1], v14 offset:20480
	ds_read_b64_tr_b16 a[2:3], v14 offset:21504
	buffer_load_dwordx4 a[76:79], v5, s[44:47], s67 offen offset:1024 sc1
	v_mfma_f32_32x32x16_bf16 v[64:79], a[12:15], a[96:99], v[64:79]
	ds_read_b64_tr_b16 a[4:5], v15 offset:20480
	ds_read_b64_tr_b16 a[6:7], v15 offset:21504
	s_waitcnt vmcnt(12) lgkmcnt(4)
	v_mfma_f32_32x32x16_bf16 v[48:63], a[16:19], a[100:103], v[48:63]
	ds_read_b64_tr_b16 a[8:9], v14 offset:22528
	ds_read_b64_tr_b16 a[10:11], v14 offset:23552
	buffer_load_dwordx4 a[80:83], v5, s[44:47], s67 offen offset:2048 sc1
	v_mfma_f32_32x32x16_bf16 v[64:79], a[20:23], a[100:103], v[64:79]
	ds_read_b64_tr_b16 a[12:13], v15 offset:22528
	ds_read_b64_tr_b16 a[14:15], v15 offset:23552
	s_waitcnt vmcnt(12) lgkmcnt(4)
	v_mfma_f32_32x32x16_bf16 v[48:63], a[0:3], a[104:107], v[48:63]
	ds_read_b64_tr_b16 a[16:17], v14 offset:24576
	ds_read_b64_tr_b16 a[18:19], v14 offset:25600
	buffer_load_dwordx4 a[84:87], v5, s[44:47], s67 offen offset:3072 sc1
	s_add_u32 s67, s67, 4096
	v_mfma_f32_32x32x16_bf16 v[64:79], a[4:7], a[104:107], v[64:79]
	ds_read_b64_tr_b16 a[20:21], v15 offset:24576
	ds_read_b64_tr_b16 a[22:23], v15 offset:25600
	s_waitcnt vmcnt(12) lgkmcnt(4)
	v_mfma_f32_32x32x16_bf16 v[48:63], a[8:11], a[108:111], v[48:63]
	ds_read_b64_tr_b16 a[0:1], v14 offset:26624
	ds_read_b64_tr_b16 a[2:3], v14 offset:27648
	v_mfma_f32_32x32x16_bf16 v[64:79], a[12:15], a[108:111], v[64:79]
	ds_read_b64_tr_b16 a[4:5], v15 offset:26624
	ds_read_b64_tr_b16 a[6:7], v15 offset:27648
	s_waitcnt vmcnt(11) lgkmcnt(4)
	v_mfma_f32_32x32x16_bf16 v[48:63], a[16:19], a[112:115], v[48:63]
	ds_read_b64_tr_b16 a[8:9], v14 offset:28672
	ds_read_b64_tr_b16 a[10:11], v14 offset:29696
	v_mfma_f32_32x32x16_bf16 v[64:79], a[20:23], a[112:115], v[64:79]
	ds_read_b64_tr_b16 a[12:13], v15 offset:28672
	ds_read_b64_tr_b16 a[14:15], v15 offset:29696
	s_waitcnt vmcnt(10) lgkmcnt(4)
	v_mfma_f32_32x32x16_bf16 v[48:63], a[0:3], a[116:119], v[48:63]
	ds_read_b64_tr_b16 a[16:17], v14 offset:30720
	ds_read_b64_tr_b16 a[18:19], v14 offset:31744
	v_mfma_f32_32x32x16_bf16 v[64:79], a[4:7], a[116:119], v[64:79]
	ds_read_b64_tr_b16 a[20:21], v15 offset:30720
	ds_read_b64_tr_b16 a[22:23], v15 offset:31744
	s_waitcnt vmcnt(9) lgkmcnt(4)
	v_mfma_f32_32x32x16_bf16 v[48:63], a[8:11], a[120:123], v[48:63]
	ds_read_b64_tr_b16 a[0:1], v14 offset:32768
	ds_read_b64_tr_b16 a[2:3], v14 offset:33792
	v_mfma_f32_32x32x16_bf16 v[64:79], a[12:15], a[120:123], v[64:79]
	ds_read_b64_tr_b16 a[4:5], v15 offset:32768
	ds_read_b64_tr_b16 a[6:7], v15 offset:33792
	s_waitcnt vmcnt(8) lgkmcnt(4)
	v_mfma_f32_32x32x16_bf16 v[48:63], a[16:19], a[124:127], v[48:63]
	ds_read_b64_tr_b16 a[8:9], v14 offset:34816
	ds_read_b64_tr_b16 a[10:11], v14 offset:35840
	v_mfma_f32_32x32x16_bf16 v[64:79], a[20:23], a[124:127], v[64:79]
	ds_read_b64_tr_b16 a[12:13], v15 offset:34816
	ds_read_b64_tr_b16 a[14:15], v15 offset:35840
	s_waitcnt vmcnt(7) lgkmcnt(4)
	v_mfma_f32_32x32x16_bf16 v[48:63], a[0:3], a[24:27], v[48:63]
	ds_read_b64_tr_b16 a[16:17], v14 offset:36864
	ds_read_b64_tr_b16 a[18:19], v14 offset:37888
	v_mfma_f32_32x32x16_bf16 v[64:79], a[4:7], a[24:27], v[64:79]
	ds_read_b64_tr_b16 a[20:21], v15 offset:36864
	ds_read_b64_tr_b16 a[22:23], v15 offset:37888
	s_waitcnt vmcnt(6) lgkmcnt(4)
	v_mfma_f32_32x32x16_bf16 v[48:63], a[8:11], a[28:31], v[48:63]
	ds_read_b64_tr_b16 a[0:1], v14 offset:38912
	ds_read_b64_tr_b16 a[2:3], v14 offset:39936
	v_mfma_f32_32x32x16_bf16 v[64:79], a[12:15], a[28:31], v[64:79]
	ds_read_b64_tr_b16 a[4:5], v15 offset:38912
	ds_read_b64_tr_b16 a[6:7], v15 offset:39936
	s_waitcnt vmcnt(5) lgkmcnt(4)
	v_mfma_f32_32x32x16_bf16 v[48:63], a[16:19], a[32:35], v[48:63]
	ds_read_b64_tr_b16 a[8:9], v14 offset:40960
	ds_read_b64_tr_b16 a[10:11], v14 offset:41984
	v_mfma_f32_32x32x16_bf16 v[64:79], a[20:23], a[32:35], v[64:79]
	ds_read_b64_tr_b16 a[12:13], v15 offset:40960
	ds_read_b64_tr_b16 a[14:15], v15 offset:41984
	s_waitcnt vmcnt(4) lgkmcnt(4)
	v_mfma_f32_32x32x16_bf16 v[48:63], a[0:3], a[36:39], v[48:63]
	ds_read_b64_tr_b16 a[16:17], v14 offset:43008
	ds_read_b64_tr_b16 a[18:19], v14 offset:44032
	v_mfma_f32_32x32x16_bf16 v[64:79], a[4:7], a[36:39], v[64:79]
	ds_read_b64_tr_b16 a[20:21], v15 offset:43008
	ds_read_b64_tr_b16 a[22:23], v15 offset:44032
	s_waitcnt vmcnt(3) lgkmcnt(4)
	v_mfma_f32_32x32x16_bf16 v[48:63], a[8:11], a[72:75], v[48:63]
	ds_read_b64_tr_b16 a[0:1], v14 offset:45056
	ds_read_b64_tr_b16 a[2:3], v14 offset:46080
	v_mfma_f32_32x32x16_bf16 v[64:79], a[12:15], a[72:75], v[64:79]
	ds_read_b64_tr_b16 a[4:5], v15 offset:45056
	ds_read_b64_tr_b16 a[6:7], v15 offset:46080
	s_waitcnt vmcnt(2) lgkmcnt(4)
	v_mfma_f32_32x32x16_bf16 v[48:63], a[16:19], a[76:79], v[48:63]
	ds_read_b64_tr_b16 a[8:9], v14 offset:47104
	ds_read_b64_tr_b16 a[10:11], v14 offset:48128
	v_mfma_f32_32x32x16_bf16 v[64:79], a[20:23], a[76:79], v[64:79]
	ds_read_b64_tr_b16 a[12:13], v15 offset:47104
	ds_read_b64_tr_b16 a[14:15], v15 offset:48128
	s_cmp_lg_u32 s53, 0
	s_cbranch_scc1 L_dskip
	s_waitcnt vmcnt(1) lgkmcnt(4)
	v_mfma_f32_32x32x16_bf16 v[48:63], a[0:3], a[80:83], v[48:63]
	v_mfma_f32_32x32x16_bf16 v[64:79], a[4:7], a[80:83], v[64:79]
	s_waitcnt vmcnt(0) lgkmcnt(0)
	v_mfma_f32_32x32x16_bf16 v[48:63], a[8:11], a[84:87], v[48:63]
	v_mfma_f32_32x32x16_bf16 v[64:79], a[12:15], a[84:87], v[64:79]
L_dskip:
	s_nop 10
	ds_write_b128 v18, v[48:51]
	ds_write_b128 v19, v[52:55]
	ds_write_b128 v20, v[56:59]
	ds_write_b128 v21, v[60:63]
	ds_write_b128 v22, v[64:67]
	ds_write_b128 v23, v[68:71]
	ds_write_b128 v24, v[72:75]
	ds_write_b128 v25, v[76:79]
	s_waitcnt lgkmcnt(0)
	s_barrier
	ds_read_b128 v[48:51], v26 offset:0
	ds_read_b128 v[52:55], v27 offset:0
	ds_read_b128 v[56:59], v26 offset:32768
	ds_read_b128 v[60:63], v27 offset:32768
	ds_read_b128 v[64:67], v26 offset:2048
	ds_read_b128 v[68:71], v27 offset:2048
	ds_read_b128 v[72:75], v26 offset:34816
	ds_read_b128 v[76:79], v27 offset:34816
	s_waitcnt lgkmcnt(5)
	v_pk_add_f32 v[48:49], v[48:49], v[56:57]
	v_pk_add_f32 v[50:51], v[50:51], v[58:59]
	s_waitcnt lgkmcnt(4)
	v_pk_add_f32 v[52:53], v[52:53], v[60:61]
	v_pk_add_f32 v[54:55], v[54:55], v[62:63]
	v_cvt_pk_bf16_f32 v6, v48, v49
	v_cvt_pk_bf16_f32 v7, v50, v51
	v_cvt_pk_bf16_f32 v8, v52, v53
	v_cvt_pk_bf16_f32 v9, v54, v55
	buffer_store_dwordx4 v[6:9], v28, s[36:39], s56 offen
	s_add_u32 s56, s56, 8192
	s_waitcnt lgkmcnt(1)
	v_pk_add_f32 v[64:65], v[64:65], v[72:73]
	v_pk_add_f32 v[66:67], v[66:67], v[74:75]
	s_waitcnt lgkmcnt(0)
	v_pk_add_f32 v[68:69], v[68:69], v[76:77]
	v_pk_add_f32 v[70:71], v[70:71], v[78:79]
	v_cvt_pk_bf16_f32 v10, v64, v65
	v_cvt_pk_bf16_f32 v11, v66, v67
	v_cvt_pk_bf16_f32 v12, v68, v69
	v_cvt_pk_bf16_f32 v13, v70, v71
	buffer_store_dwordx4 v[10:13], v28, s[36:39], s56 offen
	s_add_u32 s56, s56, 8192
	s_nop 0
L_end:
	s_endpgm
L_init:
	v_mov_b32 v64, 0
	v_mov_b32 v65, 0
	v_mov_b32 v66, 0
	v_mov_b32 v67, 0
	s_mov_b32 s46, 12582912
	s_mov_b32 s47, 0x20000
	v_lshlrev_b32 v63, 4, v0
	s_lshl_b32 s50, s2, 12
	s_add_u32 s50, s50, 10485760
	buffer_store_dwordx4 v[64:67], v63, s[44:47], s50 offen offset:0 sc1
	buffer_store_dwordx4 v[64:67], v63, s[44:47], s50 offen offset:1024 sc1
	buffer_store_dwordx4 v[64:67], v63, s[44:47], s50 offen offset:2048 sc1
	buffer_store_dwordx4 v[64:67], v63, s[44:47], s50 offen offset:3072 sc1
	s_nop 1
	s_branch L_noinit
L_hsetup:
	s_setprio 1
	s_load_dwordx2 s[12:13], s[0:1], 8
	s_load_dwordx2 s[40:41], s[0:1], 72
	s_load_dwordx2 s[16:17], s[0:1], 16
	s_load_dwordx2 s[20:21], s[0:1], 32
	s_load_dwordx2 s[28:29], s[0:1], 48
	s_mov_b32 s14, 1572864
	s_mov_b32 s15, 0x20000
	s_mov_b32 s42, 256
	s_mov_b32 s43, 0x20000
	s_mov_b32 s18, 524288
	s_mov_b32 s19, 0x20000
	s_mov_b32 s22, 1409024
	s_mov_b32 s23, 0x20000
	s_mov_b32 s30, 1409024
	s_mov_b32 s31, 0x20000
	v_and_b32 v2, 15, v4
	v_lshlrev_b32 v2, 4, v2
	v_xor_b32 v2, v2, v5
	v_lshl_add_u32 v60, v4, 8, v2
	v_xor_b32 v61, 128, v60
	v_mov_b32 v56, 0
	v_mov_b32 v57, 0
	s_mov_b32 s63, 0xffff0000
	s_mov_b32 s6, 0x3f803f80
	v_and_b32 v0, 63, v0
	v_lshlrev_b32 v1, 7, v0
	s_bfe_u32 s58, s2, 0x20003
	s_bfe_u32 s3, s69, 0x20006
	s_and_b32 s51, s2, 1
	s_lshl1_add_u32 s5, s58, s51
	s_and_b32 s50, s48, 1
	s_xor_b32 s58, s58, 2
	s_lshl1_add_u32 s50, s58, s50
	s_mul_i32 s49, s51, 22
	s_add_u32 s65, s49, s50
	s_lshl_b32 s65, s65, 1
	s_sub_u32 s51, 6, s51
	s_cmp_lt_u32 s50, s51
	s_cselect_b32 s64, 0, 0x40000000
	s_min_u32 s51, s51, s50
	s_add_u32 s49, s49, s51
	s_lshl1_add_u32 s49, s50, s49
	s_mov_b32 s46, 12582912
	s_mov_b32 s47, 0x20000
	buffer_load_dwordx4 v[84:87], v62, s[8:11], s55 offen offset:0
	buffer_load_dwordx4 v[92:95], v62, s[8:11], s55 offen offset:128
	s_addk_i32 s55, 256
	s_bitset0_b32 s55, 10
	v_lshrrev_b32 v2, 3, v0
	v_mul_u32_u24 v4, 3072, v2
	v_and_b32 v2, 2, v2
	v_and_b32 v3, 7, v0
	v_xor_b32 v5, v3, v2
	v_lshl_add_u32 v5, v5, 4, v4
	v_xor_b32 v6, 64, v5
	v_add_u32 v7, 47104, v5
	v_add_u32 v8, 70656, v6
	v_add_u32 v6, 23552, v6
	s_lshl_b32 s52, s5, 7
	s_mul_i32 s50, s3, 98304
	s_add_u32 s52, s52, s50
	s_lshl_b32 s54, s3, 12
	v_lshrrev_b32 v2, 3, v0
	v_and_b32 v3, 2, v2
	v_lshlrev_b32 v3, 1, v3
	v_and_b32 v4, 7, v0
	v_xor_b32 v3, v3, v4
	v_lshlrev_b32 v3, 4, v3
	v_lshl_add_u32 v9, v2, 10, v3
	s_lshr_b32 s50, s3, 1
	s_mul_i32 s70, s50, 720896
	s_lshl_b32 s53, s50, 15
	s_mul_i32 s58, s50, 49152
	s_and_b32 s50, s3, 1
	s_lshl_b32 s51, s50, 13
	s_add_u32 s70, s70, s51
	s_lshl_b32 s51, s5, 7
	s_add_u32 s70, s70, s51
	s_sub_u32 s71, s70, s53
	s_lshl_b32 s50, s50, 10
	s_add_u32 s53, s53, s50
	s_add_u32 s53, s53, 98304
	s_add_u32 s58, s58, s50
	buffer_load_dwordx4 v[100:103], v62, s[8:11], s55 offen offset:0
	buffer_load_dwordx4 v[108:111], v62, s[8:11], s55 offen offset:128
	s_addk_i32 s55, 256
	s_bitset0_b32 s55, 10
	buffer_load_dwordx4 v[116:119], v62, s[8:11], s55 offen offset:0
	buffer_load_dwordx4 v[124:127], v62, s[8:11], s55 offen offset:128
	s_add_u32 s62, s7, 0
	s_and_b32 s62, s62, 3
	s_mul_i32 s56, s62, 393216
	s_add_u32 m0, s54, 65536
	s_add_u32 s56, s56, s52
	s_add_u32 s56, s56, 1024
	s_waitcnt lgkmcnt(0)
	buffer_load_dwordx4 v5, s[12:15], s56 offen offset:0 lds
	buffer_load_dwordx4 v6, s[12:15], s56 offen offset:1024 lds
	buffer_load_dwordx4 v7, s[12:15], s56 offen offset:2048 lds
	buffer_load_dwordx4 v8, s[12:15], s56 offen offset:3072 lds
	s_waitcnt vmcnt(11)
	v_dot2c_f32_bf16 v56, s6, v68
	v_dot2c_f32_bf16 v57, v68, v68
	v_dot2c_f32_bf16 v56, s6, v69
	v_dot2c_f32_bf16 v57, v69, v69
	v_dot2c_f32_bf16 v56, s6, v70
	v_dot2c_f32_bf16 v57, v70, v70
	v_dot2c_f32_bf16 v56, s6, v71
	v_dot2c_f32_bf16 v57, v71, v71
	v_lshlrev_b32 v64, 16, v68
	v_and_b32 v65, s63, v68
	v_lshlrev_b32 v66, 16, v69
	v_and_b32 v67, s63, v69
	v_lshlrev_b32 v68, 16, v70
	v_and_b32 v69, s63, v70
	v_lshlrev_b32 v70, 16, v71
	v_and_b32 v71, s63, v71
	s_waitcnt vmcnt(10)
	v_dot2c_f32_bf16 v56, s6, v76
	v_dot2c_f32_bf16 v57, v76, v76
	v_dot2c_f32_bf16 v56, s6, v77
	v_dot2c_f32_bf16 v57, v77, v77
	v_dot2c_f32_bf16 v56, s6, v78
	v_dot2c_f32_bf16 v57, v78, v78
	v_dot2c_f32_bf16 v56, s6, v79
	v_dot2c_f32_bf16 v57, v79, v79
	v_lshlrev_b32 v72, 16, v76
	v_and_b32 v73, s63, v76
	v_lshlrev_b32 v74, 16, v77
	v_and_b32 v75, s63, v77
	v_lshlrev_b32 v76, 16, v78
	v_and_b32 v77, s63, v78
	v_lshlrev_b32 v78, 16, v79
	v_and_b32 v79, s63, v79
	s_waitcnt vmcnt(9)
	v_dot2c_f32_bf16 v56, s6, v84
	v_dot2c_f32_bf16 v57, v84, v84
	v_dot2c_f32_bf16 v56, s6, v85
	v_dot2c_f32_bf16 v57, v85, v85
	v_dot2c_f32_bf16 v56, s6, v86
	v_dot2c_f32_bf16 v57, v86, v86
	v_dot2c_f32_bf16 v56, s6, v87
	v_dot2c_f32_bf16 v57, v87, v87
	v_lshlrev_b32 v80, 16, v84
	v_and_b32 v81, s63, v84
	v_lshlrev_b32 v82, 16, v85
	v_and_b32 v83, s63, v85
	v_lshlrev_b32 v84, 16, v86
	v_and_b32 v85, s63, v86
	v_lshlrev_b32 v86, 16, v87
	v_and_b32 v87, s63, v87
	s_waitcnt vmcnt(8)
	v_dot2c_f32_bf16 v56, s6, v92
	v_dot2c_f32_bf16 v57, v92, v92
	v_dot2c_f32_bf16 v56, s6, v93
	v_dot2c_f32_bf16 v57, v93, v93
	v_dot2c_f32_bf16 v56, s6, v94
	v_dot2c_f32_bf16 v57, v94, v94
	v_dot2c_f32_bf16 v56, s6, v95
	v_dot2c_f32_bf16 v57, v95, v95
	v_lshlrev_b32 v88, 16, v92
	v_and_b32 v89, s63, v92
	v_lshlrev_b32 v90, 16, v93
	v_and_b32 v91, s63, v93
	v_lshlrev_b32 v92, 16, v94
	v_and_b32 v93, s63, v94
	v_lshlrev_b32 v94, 16, v95
	v_and_b32 v95, s63, v95
	s_waitcnt vmcnt(7)
	v_dot2c_f32_bf16 v56, s6, v100
	v_dot2c_f32_bf16 v57, v100, v100
	v_dot2c_f32_bf16 v56, s6, v101
	v_dot2c_f32_bf16 v57, v101, v101
	v_dot2c_f32_bf16 v56, s6, v102
	v_dot2c_f32_bf16 v57, v102, v102
	v_dot2c_f32_bf16 v56, s6, v103
	v_dot2c_f32_bf16 v57, v103, v103
	v_lshlrev_b32 v96, 16, v100
	v_and_b32 v97, s63, v100
	v_lshlrev_b32 v98, 16, v101
	v_and_b32 v99, s63, v101
	v_lshlrev_b32 v100, 16, v102
	v_and_b32 v101, s63, v102
	v_lshlrev_b32 v102, 16, v103
	v_and_b32 v103, s63, v103
	s_waitcnt vmcnt(6)
	v_dot2c_f32_bf16 v56, s6, v108
	v_dot2c_f32_bf16 v57, v108, v108
	v_dot2c_f32_bf16 v56, s6, v109
	v_dot2c_f32_bf16 v57, v109, v109
	v_dot2c_f32_bf16 v56, s6, v110
	v_dot2c_f32_bf16 v57, v110, v110
	v_dot2c_f32_bf16 v56, s6, v111
	v_dot2c_f32_bf16 v57, v111, v111
	v_lshlrev_b32 v104, 16, v108
	v_and_b32 v105, s63, v108
	v_lshlrev_b32 v106, 16, v109
	v_and_b32 v107, s63, v109
	v_lshlrev_b32 v108, 16, v110
	v_and_b32 v109, s63, v110
	v_lshlrev_b32 v110, 16, v111
	v_and_b32 v111, s63, v111
	s_waitcnt vmcnt(5)
	v_dot2c_f32_bf16 v56, s6, v116
	v_dot2c_f32_bf16 v57, v116, v116
	v_dot2c_f32_bf16 v56, s6, v117
	v_dot2c_f32_bf16 v57, v117, v117
	v_dot2c_f32_bf16 v56, s6, v118
	v_dot2c_f32_bf16 v57, v118, v118
	v_dot2c_f32_bf16 v56, s6, v119
	v_dot2c_f32_bf16 v57, v119, v119
	v_lshlrev_b32 v112, 16, v116
	v_and_b32 v113, s63, v116
	v_lshlrev_b32 v114, 16, v117
	v_and_b32 v115, s63, v117
	v_lshlrev_b32 v116, 16, v118
	v_and_b32 v117, s63, v118
	v_lshlrev_b32 v118, 16, v119
	v_and_b32 v119, s63, v119
	s_waitcnt vmcnt(4)
	v_dot2c_f32_bf16 v56, s6, v124
	v_dot2c_f32_bf16 v57, v124, v124
	v_dot2c_f32_bf16 v56, s6, v125
	v_dot2c_f32_bf16 v57, v125, v125
	v_dot2c_f32_bf16 v56, s6, v126
	v_dot2c_f32_bf16 v57, v126, v126
	v_dot2c_f32_bf16 v56, s6, v127
	v_dot2c_f32_bf16 v57, v127, v127
	v_lshlrev_b32 v120, 16, v124
	v_and_b32 v121, s63, v124
	v_lshlrev_b32 v122, 16, v125
	v_add_f32_dpp v56, v56, v56 quad_perm:[1,0,3,2] row_mask:0xf bank_mask:0xf
	v_add_f32_dpp v57, v57, v57 quad_perm:[1,0,3,2] row_mask:0xf bank_mask:0xf
	v_and_b32 v123, s63, v125
	v_add_f32_dpp v56, v56, v56 quad_perm:[2,3,0,1] row_mask:0xf bank_mask:0xf
	v_add_f32_dpp v57, v57, v57 quad_perm:[2,3,0,1] row_mask:0xf bank_mask:0xf
	v_lshlrev_b32 v124, 16, v126
	v_add_f32_dpp v56, v56, v56 row_half_mirror row_mask:0xf bank_mask:0xf
	v_add_f32_dpp v57, v57, v57 row_half_mirror row_mask:0xf bank_mask:0xf
	v_and_b32 v125, s63, v126
	v_mul_f32 v56, 0x3b000000, v56
	v_mul_f32 v57, 0x3b000000, v57
	v_fma_f32 v57, -v56, v56, v57
	v_max_f32 v57, 0, v57
	v_add_f32 v57, 0x3727c5ac, v57
	v_rsq_f32 v58, v57
	v_lshlrev_b32 v126, 16, v127
	v_and_b32 v127, s63, v127
	v_mul_f32_e64 v59, -v56, v58
	v_pk_fma_f32 v[64:65], v[64:65], v[58:59], v[58:59] op_sel:[0,0,1] op_sel_hi:[1,0,1]
	v_pk_fma_f32 v[66:67], v[66:67], v[58:59], v[58:59] op_sel:[0,0,1] op_sel_hi:[1,0,1]
	v_pk_fma_f32 v[68:69], v[68:69], v[58:59], v[58:59] op_sel:[0,0,1] op_sel_hi:[1,0,1]
	v_pk_fma_f32 v[70:71], v[70:71], v[58:59], v[58:59] op_sel:[0,0,1] op_sel_hi:[1,0,1]
	v_cvt_pk_bf16_f32 v64, v64, v65
	v_cvt_pk_bf16_f32 v65, v66, v67
	v_cvt_pk_bf16_f32 v66, v68, v69
	v_cvt_pk_bf16_f32 v67, v70, v71
	ds_write_b128 v60, v[64:67] offset:0
	v_pk_fma_f32 v[72:73], v[72:73], v[58:59], v[58:59] op_sel:[0,0,1] op_sel_hi:[1,0,1]
	v_pk_fma_f32 v[74:75], v[74:75], v[58:59], v[58:59] op_sel:[0,0,1] op_sel_hi:[1,0,1]
	v_pk_fma_f32 v[76:77], v[76:77], v[58:59], v[58:59] op_sel:[0,0,1] op_sel_hi:[1,0,1]
	v_pk_fma_f32 v[78:79], v[78:79], v[58:59], v[58:59] op_sel:[0,0,1] op_sel_hi:[1,0,1]
	v_cvt_pk_bf16_f32 v72, v72, v73
	v_cvt_pk_bf16_f32 v73, v74, v75
	v_cvt_pk_bf16_f32 v74, v76, v77
	v_cvt_pk_bf16_f32 v75, v78, v79
	ds_write_b128 v61, v[72:75] offset:0
	v_pk_fma_f32 v[80:81], v[80:81], v[58:59], v[58:59] op_sel:[0,0,1] op_sel_hi:[1,0,1]
	v_pk_fma_f32 v[82:83], v[82:83], v[58:59], v[58:59] op_sel:[0,0,1] op_sel_hi:[1,0,1]
	v_pk_fma_f32 v[84:85], v[84:85], v[58:59], v[58:59] op_sel:[0,0,1] op_sel_hi:[1,0,1]
	v_pk_fma_f32 v[86:87], v[86:87], v[58:59], v[58:59] op_sel:[0,0,1] op_sel_hi:[1,0,1]
	v_cvt_pk_bf16_f32 v80, v80, v81
	v_cvt_pk_bf16_f32 v81, v82, v83
	v_cvt_pk_bf16_f32 v82, v84, v85
	v_cvt_pk_bf16_f32 v83, v86, v87
	ds_write_b128 v60, v[80:83] offset:16384
	v_pk_fma_f32 v[88:89], v[88:89], v[58:59], v[58:59] op_sel:[0,0,1] op_sel_hi:[1,0,1]
	v_pk_fma_f32 v[90:91], v[90:91], v[58:59], v[58:59] op_sel:[0,0,1] op_sel_hi:[1,0,1]
	v_pk_fma_f32 v[92:93], v[92:93], v[58:59], v[58:59] op_sel:[0,0,1] op_sel_hi:[1,0,1]
	v_pk_fma_f32 v[94:95], v[94:95], v[58:59], v[58:59] op_sel:[0,0,1] op_sel_hi:[1,0,1]
	v_cvt_pk_bf16_f32 v88, v88, v89
	v_cvt_pk_bf16_f32 v89, v90, v91
	v_cvt_pk_bf16_f32 v90, v92, v93
	v_cvt_pk_bf16_f32 v91, v94, v95
	ds_write_b128 v61, v[88:91] offset:16384
	v_pk_fma_f32 v[96:97], v[96:97], v[58:59], v[58:59] op_sel:[0,0,1] op_sel_hi:[1,0,1]
	v_pk_fma_f32 v[98:99], v[98:99], v[58:59], v[58:59] op_sel:[0,0,1] op_sel_hi:[1,0,1]
	v_pk_fma_f32 v[100:101], v[100:101], v[58:59], v[58:59] op_sel:[0,0,1] op_sel_hi:[1,0,1]
	v_pk_fma_f32 v[102:103], v[102:103], v[58:59], v[58:59] op_sel:[0,0,1] op_sel_hi:[1,0,1]
	v_cvt_pk_bf16_f32 v96, v96, v97
	v_cvt_pk_bf16_f32 v97, v98, v99
	v_cvt_pk_bf16_f32 v98, v100, v101
	v_cvt_pk_bf16_f32 v99, v102, v103
	ds_write_b128 v60, v[96:99] offset:32768
	v_pk_fma_f32 v[104:105], v[104:105], v[58:59], v[58:59] op_sel:[0,0,1] op_sel_hi:[1,0,1]
	v_pk_fma_f32 v[106:107], v[106:107], v[58:59], v[58:59] op_sel:[0,0,1] op_sel_hi:[1,0,1]
	v_pk_fma_f32 v[108:109], v[108:109], v[58:59], v[58:59] op_sel:[0,0,1] op_sel_hi:[1,0,1]
	v_pk_fma_f32 v[110:111], v[110:111], v[58:59], v[58:59] op_sel:[0,0,1] op_sel_hi:[1,0,1]
	v_cvt_pk_bf16_f32 v104, v104, v105
	v_cvt_pk_bf16_f32 v105, v106, v107
	v_cvt_pk_bf16_f32 v106, v108, v109
	v_cvt_pk_bf16_f32 v107, v110, v111
	ds_write_b128 v61, v[104:107] offset:32768
	v_pk_fma_f32 v[112:113], v[112:113], v[58:59], v[58:59] op_sel:[0,0,1] op_sel_hi:[1,0,1]
	v_pk_fma_f32 v[114:115], v[114:115], v[58:59], v[58:59] op_sel:[0,0,1] op_sel_hi:[1,0,1]
	v_pk_fma_f32 v[116:117], v[116:117], v[58:59], v[58:59] op_sel:[0,0,1] op_sel_hi:[1,0,1]
	v_pk_fma_f32 v[118:119], v[118:119], v[58:59], v[58:59] op_sel:[0,0,1] op_sel_hi:[1,0,1]
	v_cvt_pk_bf16_f32 v112, v112, v113
	v_cvt_pk_bf16_f32 v113, v114, v115
	v_cvt_pk_bf16_f32 v114, v116, v117
	v_cvt_pk_bf16_f32 v115, v118, v119
	ds_write_b128 v60, v[112:115] offset:49152
	v_pk_fma_f32 v[120:121], v[120:121], v[58:59], v[58:59] op_sel:[0,0,1] op_sel_hi:[1,0,1]
	v_pk_fma_f32 v[122:123], v[122:123], v[58:59], v[58:59] op_sel:[0,0,1] op_sel_hi:[1,0,1]
	v_pk_fma_f32 v[124:125], v[124:125], v[58:59], v[58:59] op_sel:[0,0,1] op_sel_hi:[1,0,1]
	v_pk_fma_f32 v[126:127], v[126:127], v[58:59], v[58:59] op_sel:[0,0,1] op_sel_hi:[1,0,1]
	v_cvt_pk_bf16_f32 v120, v120, v121
	v_cvt_pk_bf16_f32 v121, v122, v123
	v_cvt_pk_bf16_f32 v122, v124, v125
	v_cvt_pk_bf16_f32 v123, v126, v127
	ds_write_b128 v61, v[120:123] offset:49152
	s_setprio 1
	s_add_u32 s55, s7, 1
	s_and_b32 s55, s55, 3
	s_mul_i32 s56, s55, 393216
	s_add_u32 m0, s54, 81920
	s_add_u32 s56, s56, s52
	s_add_u32 s56, s56, 1024
	buffer_load_dwordx4 v5, s[12:15], s56 offen offset:0 lds
	buffer_load_dwordx4 v6, s[12:15], s56 offen offset:1024 lds
	buffer_load_dwordx4 v7, s[12:15], s56 offen offset:2048 lds
	buffer_load_dwordx4 v8, s[12:15], s56 offen offset:3072 lds
	s_add_u32 s55, s7, 1
	s_and_b32 s55, s55, 3
	s_mul_i32 s56, s55, 393216
	s_add_u32 m0, s54, 131072
	s_add_u32 s56, s56, s52
	s_add_u32 s56, s56, 2048
	buffer_load_dwordx4 v5, s[12:15], s56 offen offset:0 lds
	buffer_load_dwordx4 v6, s[12:15], s56 offen offset:1024 lds
	buffer_load_dwordx4 v7, s[12:15], s56 offen offset:2048 lds
	buffer_load_dwordx4 v8, s[12:15], s56 offen offset:3072 lds
	s_waitcnt vmcnt(8)
	s_waitcnt lgkmcnt(0)
	s_barrier
	s_add_u32 s55, s7, 2
	s_and_b32 s55, s55, 3
	s_mul_i32 s56, s55, 393216
	s_add_u32 m0, s54, 98304
	s_add_u32 s56, s56, s52
	s_add_u32 s56, s56, 1024
	buffer_load_dwordx4 v5, s[12:15], s56 offen offset:0 lds
	buffer_load_dwordx4 v6, s[12:15], s56 offen offset:1024 lds
	buffer_load_dwordx4 v7, s[12:15], s56 offen offset:2048 lds
	buffer_load_dwordx4 v8, s[12:15], s56 offen offset:3072 lds
	s_add_u32 s55, s7, 2
	s_and_b32 s55, s55, 3
	s_mul_i32 s56, s55, 393216
	s_add_u32 m0, s54, 147456
	s_add_u32 s56, s56, s52
	s_add_u32 s56, s56, 2048
	buffer_load_dwordx4 v5, s[12:15], s56 offen offset:0 lds
	buffer_load_dwordx4 v6, s[12:15], s56 offen offset:1024 lds
	buffer_load_dwordx4 v7, s[12:15], s56 offen offset:2048 lds
	buffer_load_dwordx4 v8, s[12:15], s56 offen offset:3072 lds
	s_load_dwordx2 s[24:25], s[0:1], 40
	s_load_dwordx2 s[32:33], s[0:1], 56
	s_mov_b32 s26, 2752
	s_mov_b32 s27, 0x20000
	s_mov_b32 s34, 1024
	s_mov_b32 s35, 0x20000
	s_waitcnt vmcnt(8)
	s_waitcnt lgkmcnt(0)
	s_barrier
	s_add_u32 s55, s7, 3
	s_and_b32 s55, s55, 3
	s_mul_i32 s56, s55, 393216
	s_add_u32 m0, s54, 65536
	s_add_u32 s56, s56, s52
	s_add_u32 s56, s56, 1024
	buffer_load_dwordx4 v5, s[12:15], s56 offen offset:0 lds
	buffer_load_dwordx4 v6, s[12:15], s56 offen offset:1024 lds
	buffer_load_dwordx4 v7, s[12:15], s56 offen offset:2048 lds
	buffer_load_dwordx4 v8, s[12:15], s56 offen offset:3072 lds
	s_add_u32 s55, s7, 3
	s_and_b32 s55, s55, 3
	s_mul_i32 s56, s55, 393216
	s_add_u32 m0, s54, 114688
	s_add_u32 s56, s56, s52
	s_add_u32 s56, s56, 2048
	buffer_load_dwordx4 v5, s[12:15], s56 offen offset:0 lds
	buffer_load_dwordx4 v6, s[12:15], s56 offen offset:1024 lds
	buffer_load_dwordx4 v7, s[12:15], s56 offen offset:2048 lds
	buffer_load_dwordx4 v8, s[12:15], s56 offen offset:3072 lds
	s_waitcnt vmcnt(8)
	s_barrier
	s_add_u32 s55, s7, 0
	s_and_b32 s55, s55, 3
	s_mul_i32 s56, s55, 393216
	s_add_u32 m0, s54, 0
	s_add_u32 s56, s56, s52
	buffer_load_dwordx4 v5, s[12:15], s56 offen offset:0 lds
	buffer_load_dwordx4 v6, s[12:15], s56 offen offset:1024 lds
	buffer_load_dwordx4 v7, s[12:15], s56 offen offset:2048 lds
	buffer_load_dwordx4 v8, s[12:15], s56 offen offset:3072 lds
	s_add_u32 s55, s7, 1
	s_and_b32 s55, s55, 3
	s_mul_i32 s56, s55, 393216
	s_add_u32 m0, s54, 16384
	s_add_u32 s56, s56, s52
	buffer_load_dwordx4 v5, s[12:15], s56 offen offset:0 lds
	buffer_load_dwordx4 v6, s[12:15], s56 offen offset:1024 lds
	buffer_load_dwordx4 v7, s[12:15], s56 offen offset:2048 lds
	buffer_load_dwordx4 v8, s[12:15], s56 offen offset:3072 lds
	s_waitcnt vmcnt(8)
	s_barrier
	s_lshl_b32 s50, s3, 8
	s_mov_b64 exec, 1
	buffer_load_dword v52, v1, s[40:43], s50 offen sc1
	s_mov_b64 exec, -1
	s_add_u32 s55, s7, 2
	s_and_b32 s55, s55, 3
	s_mul_i32 s56, s55, 393216
	s_add_u32 m0, s54, 81920
	s_add_u32 s56, s56, s52
	buffer_load_dwordx4 v5, s[12:15], s56 offen offset:0 lds
	buffer_load_dwordx4 v6, s[12:15], s56 offen offset:1024 lds
	buffer_load_dwordx4 v7, s[12:15], s56 offen offset:2048 lds
	buffer_load_dwordx4 v8, s[12:15], s56 offen offset:3072 lds
	s_add_u32 s55, s7, 3
	s_and_b32 s55, s55, 3
	s_mul_i32 s56, s55, 393216
	s_add_u32 m0, s54, 32768
	s_add_u32 s56, s56, s52
	buffer_load_dwordx4 v5, s[12:15], s56 offen offset:0 lds
	buffer_load_dwordx4 v6, s[12:15], s56 offen offset:1024 lds
	buffer_load_dwordx4 v7, s[12:15], s56 offen offset:2048 lds
	buffer_load_dwordx4 v8, s[12:15], s56 offen offset:3072 lds
	s_lshl_b32 s50, s2, 2
	s_add_u32 s50, s50, s3
	s_lshl_b32 s51, s50, 9
	s_mul_i32 s50, s50, 1408
	s_mov_b64 exec, 2047
	buffer_load_dword a126, v1, s[28:31], s50 offen
	s_mov_b64 exec, 15
	buffer_load_dword a126, v1, s[16:19], s51 offen
	s_mov_b64 exec, 2047
	buffer_load_dword a126, v1, s[20:23], s50 offen
	s_lshl_b32 s50, s49, 6
	s_lshl_b32 s51, s5, 7
	s_mov_b64 exec, 3
	buffer_load_dword a126, v1, s[24:27], s50 offen
	buffer_load_dword a126, v1, s[32:35], s51 offen
	s_mov_b64 exec, -1
	s_waitcnt vmcnt(13)
	v_readfirstlane_b32 s50, v52
	s_lshl_b32 s51, s3, 8
	s_add_u32 s50, s50, s51
	s_cmp_ge_u32 s50, 20
	s_nop 1
	s_cbranch_scc1 L_init_ok
	s_mov_b32 s51, 0
L_init_poll:
	s_mov_b64 exec, 1
	buffer_load_dword v52, v1, s[40:43], 0 offen sc1
	s_mov_b64 exec, -1
	s_waitcnt vmcnt(0)
	v_readfirstlane_b32 s50, v52
	s_nop 0
	s_cmp_ge_u32 s50, 20
	s_nop 2
	s_cbranch_scc1 L_init_ok
	s_add_u32 s51, s51, 1
	s_cmp_lt_u32 s51, 262144
	s_cbranch_scc1 L_init_poll
L_init_ok:
	s_barrier
	s_setprio 0
	v_lshrrev_b32 v2, 3, v0
	v_and_b32 v4, 7, v0
	v_xor_b32 v4, v4, v2
	v_lshlrev_b32 v4, 4, v4
	v_lshl_add_u32 v50, v2, 10, v4
	s_lshl_b32 s50, s4, 2
	s_add_u32 s50, s50, s3
	s_lshl_b32 s50, s50, 14
	v_add_u32 v50, s50, v50
	v_add_u32 v2, 0, v0
	v_mul_u32_u24 v3, 5462, v2
	v_lshrrev_b32 v3, 16, v3
	v_mul_u32_u24 v4, 12, v3
	v_sub_u32 v2, v2, v4
	v_mul_u32_u24 v3, 2752, v3
	v_lshl_add_u32 v53, v2, 4, v3
	v_lshrrev_b32 v2, 3, v2
	v_mul_lo_u32 v2, s64, v2
	v_add_u32 v53, v53, v2
	v_add_u32 v2, 64, v0
	v_mul_u32_u24 v3, 5462, v2
	v_lshrrev_b32 v3, 16, v3
	v_mul_u32_u24 v4, 12, v3
	v_sub_u32 v2, v2, v4
	v_mul_u32_u24 v3, 2752, v3
	v_lshl_add_u32 v54, v2, 4, v3
	v_subrev_u32 v54, 1024, v54
	v_lshrrev_b32 v2, 3, v2
	v_mul_lo_u32 v2, s64, v2
	v_add_u32 v54, v54, v2
	v_add_u32 v2, 128, v0
	v_mul_u32_u24 v3, 5462, v2
	v_lshrrev_b32 v3, 16, v3
	v_mul_u32_u24 v4, 12, v3
	v_sub_u32 v2, v2, v4
	v_mul_u32_u24 v3, 2752, v3
	v_lshl_add_u32 v55, v2, 4, v3
	v_subrev_u32 v55, 2048, v55
	v_lshrrev_b32 v2, 3, v2
	v_mul_lo_u32 v2, s64, v2
	v_add_u32 v55, v55, v2
	v_lshlrev_b32 v51, 4, v0
	v_bfe_u32 v2, v0, 2, 2
	v_lshrrev_b32 v3, 5, v0
	v_lshl_add_u32 v3, v3, 2, v2
	v_mul_u32_u24 v3, 192, v3
	v_and_b32 v4, 3, v0
	v_lshl_add_u32 v3, v4, 3, v3
	v_bfe_u32 v4, v0, 4, 1
	v_lshl_add_u32 v56, v4, 5, v3
	s_mul_i32 s50, s3, 3072
	v_add_u32 v56, s50, v56
	v_add_u32 v57, 49152, v56
	s_waitcnt vmcnt(5)
	s_barrier
	s_setprio 0
	s_lshl_b32 s50, s3, 11
	s_add_u32 m0, s50, 73728
	s_lshl_b32 s50, s5, 7
	buffer_load_dwordx4 v50, s[8:11], s50 offen lds
	s_add_u32 m0, m0, 1024
	s_add_u32 s50, s50, 8192
	buffer_load_dwordx4 v50, s[8:11], s50 offen lds
	s_lshl_b32 s52, s3, 17
	s_lshl_b32 s50, s5, 7
	s_add_u32 s52, s52, s50
	s_lshl_b32 s69, s3, 14
	s_add_u32 s69, s69, 98304
	s_lshl_b32 s55, s48, 11
	s_mul_i32 s57, s3, 44032
	s_lshl_b32 s50, s49, 6
	s_add_u32 s57, s57, s50
	s_mul_i32 s54, s3, 3072
	s_add_u32 s56, s70, 196608
	buffer_load_dwordx4 a[0:3], v9, s[28:31], s56 offen
	s_add_u32 s56, s70, 212992
	buffer_load_dwordx4 a[4:7], v9, s[28:31], s56 offen
	s_add_u32 s56, s70, 294912
	buffer_load_dwordx4 a[8:11], v9, s[28:31], s56 offen
	s_add_u32 s56, s70, 311296
	buffer_load_dwordx4 a[12:15], v9, s[28:31], s56 offen
	s_add_u32 s56, s70, 393216
	buffer_load_dwordx4 a[16:19], v9, s[28:31], s56 offen
	s_add_u32 s56, s70, 409600
	buffer_load_dwordx4 a[20:23], v9, s[28:31], s56 offen
	s_add_u32 s56, s70, 491520
	buffer_load_dwordx4 a[24:27], v9, s[28:31], s56 offen
	s_add_u32 s56, s70, 507904
	buffer_load_dwordx4 a[28:31], v9, s[28:31], s56 offen
	v_mov_b32 v82, 0
	v_mov_b32 v83, 0
	v_mov_b32 v84, 0
	v_mov_b32 v85, 0
	v_add_u32 v2, s53, v51
	v_add_u32 v3, s58, v51
	v_add_u32 v4, s54, v51
	v_add_u32 v52, 49152, v4
	s_lshl_b32 s50, s5, 8
	s_add_u32 s50, s50, 10535040
	s_mul_i32 s51, s3, 4096
	s_add_u32 s50, s50, s51
	s_add_u32 s60, s44, s50
	s_addc_u32 s61, s45, 0
	s_mov_b32 s62, 1
	s_waitcnt vmcnt(8)
	s_cmp_lg_u32 s3, 0
	s_barrier
	s_atomic_add s62, s[60:61], 0
	s_atomic_add s62, s[60:61], 2048
	s_add_u32 m0, s55, s69
	s_lshl3_add_u32 s56, s55, s52
	buffer_load_dwordx4 v9, s[16:19], s56 offen lds
	s_addk_i32 s55, 1024
	s_bitset0_b32 s55, 14
	s_add_u32 m0, s55, s69
	s_lshl3_add_u32 s56, s55, s52
	buffer_load_dwordx4 v9, s[16:19], s56 offen lds
	s_addk_i32 s55, 1024
	s_bitset0_b32 s55, 14
	s_add_u32 m0, s55, s69
	s_lshl3_add_u32 s56, s55, s52
	buffer_load_dwordx4 v9, s[16:19], s56 offen lds
	s_addk_i32 s55, 1024
	s_bitset0_b32 s55, 14
	s_add_u32 m0, s55, s69
	s_lshl3_add_u32 s56, s55, s52
	buffer_load_dwordx4 v9, s[16:19], s56 offen lds
	s_addk_i32 s55, 1024
	s_bitset0_b32 s55, 14
	s_add_u32 m0, s55, s69
	s_lshl3_add_u32 s56, s55, s52
	buffer_load_dwordx4 v9, s[16:19], s56 offen lds
	s_addk_i32 s55, 1024
	s_bitset0_b32 s55, 14
	s_add_u32 m0, s55, s69
	s_lshl3_add_u32 s56, s55, s52
	buffer_load_dwordx4 v9, s[16:19], s56 offen lds
	s_addk_i32 s55, 1024
	s_bitset0_b32 s55, 14
	s_add_u32 m0, s55, s69
	s_lshl3_add_u32 s56, s55, s52
	buffer_load_dwordx4 v9, s[16:19], s56 offen lds
	s_addk_i32 s55, 1024
	s_bitset0_b32 s55, 14
	s_add_u32 m0, s55, s69
	s_lshl3_add_u32 s56, s55, s52
	buffer_load_dwordx4 v9, s[16:19], s56 offen lds
	s_addk_i32 s55, 1024
	s_bitset0_b32 s55, 14
	s_add_u32 m0, s55, s69
	s_lshl3_add_u32 s56, s55, s52
	buffer_load_dwordx4 v9, s[16:19], s56 offen lds
	s_addk_i32 s55, 1024
	s_bitset0_b32 s55, 14
	s_add_u32 m0, s55, s69
	s_lshl3_add_u32 s56, s55, s52
	buffer_load_dwordx4 v9, s[16:19], s56 offen lds
	s_addk_i32 s55, 1024
	s_bitset0_b32 s55, 14
	s_add_u32 m0, s55, s69
	s_lshl3_add_u32 s56, s55, s52
	buffer_load_dwordx4 v9, s[16:19], s56 offen lds
	s_addk_i32 s55, 1024
	s_bitset0_b32 s55, 14
	s_add_u32 m0, s55, s69
	s_lshl3_add_u32 s56, s55, s52
	buffer_load_dwordx4 v9, s[16:19], s56 offen lds
	s_addk_i32 s55, 1024
	s_bitset0_b32 s55, 14
	s_add_u32 m0, s55, s69
	s_lshl3_add_u32 s56, s55, s52
	buffer_load_dwordx4 v9, s[16:19], s56 offen lds
	s_addk_i32 s55, 1024
	s_bitset0_b32 s55, 14
	s_add_u32 m0, s55, s69
	s_lshl3_add_u32 s56, s55, s52
	buffer_load_dwordx4 v9, s[16:19], s56 offen lds
	s_addk_i32 s55, 1024
	s_bitset0_b32 s55, 14
	s_add_u32 m0, s55, s69
	s_lshl3_add_u32 s56, s55, s52
	buffer_load_dwordx4 v9, s[16:19], s56 offen lds
	s_addk_i32 s55, 1024
	s_bitset0_b32 s55, 14
	s_add_u32 m0, s55, s69
	s_lshl3_add_u32 s56, s55, s52
	buffer_load_dwordx4 v9, s[16:19], s56 offen lds
	s_addk_i32 s55, 1024
	s_bitset0_b32 s55, 14
	s_add_u32 m0, s54, 0
	s_add_u32 s56, s57, 0
	buffer_load_dwordx4 v53, s[20:23], s56 offen offset:0 lds
	buffer_load_dwordx4 v54, s[20:23], s56 offen offset:1024 lds
	buffer_load_dwordx4 v55, s[20:23], s56 offen offset:2048 lds
	s_add_u32 m0, s54, 12288
	s_add_u32 s56, s57, 176128
	buffer_load_dwordx4 v53, s[20:23], s56 offen offset:0 lds
	buffer_load_dwordx4 v54, s[20:23], s56 offen offset:1024 lds
	buffer_load_dwordx4 v55, s[20:23], s56 offen offset:2048 lds
	s_waitcnt vmcnt(6)
	s_barrier
	s_barrier
	s_add_u32 m0, s54, 24576
	s_add_u32 s56, s57, 352256
	buffer_load_dwordx4 v53, s[20:23], s56 offen offset:0 lds
	buffer_load_dwordx4 v54, s[20:23], s56 offen offset:1024 lds
	buffer_load_dwordx4 v55, s[20:23], s56 offen offset:2048 lds
	s_add_u32 m0, s54, 36864
	s_add_u32 s56, s57, 528384
	buffer_load_dwordx4 v53, s[20:23], s56 offen offset:0 lds
	buffer_load_dwordx4 v54, s[20:23], s56 offen offset:1024 lds
	buffer_load_dwordx4 v55, s[20:23], s56 offen offset:2048 lds
	s_add_u32 s56, s57, 704512
	buffer_load_dwordx4 v[86:89], v53, s[20:23], s56 offen offset:0
	buffer_load_dwordx4 v[90:93], v54, s[20:23], s56 offen offset:1024
	buffer_load_dwordx4 v[94:97], v55, s[20:23], s56 offen offset:2048
	s_add_u32 s56, s57, 880640
	buffer_load_dwordx4 v[98:101], v53, s[20:23], s56 offen offset:0
	buffer_load_dwordx4 v[102:105], v54, s[20:23], s56 offen offset:1024
	buffer_load_dwordx4 v[106:109], v55, s[20:23], s56 offen offset:2048
	s_add_u32 s56, s57, 1056768
	buffer_load_dwordx4 v[110:113], v53, s[20:23], s56 offen offset:0
	buffer_load_dwordx4 v[114:117], v54, s[20:23], s56 offen offset:1024
	buffer_load_dwordx4 v[118:121], v55, s[20:23], s56 offen offset:2048
	s_add_u32 s56, s57, 1232896
	buffer_load_dwordx4 v[10:13], v53, s[20:23], s56 offen offset:0
	buffer_load_dwordx4 v[14:17], v54, s[20:23], s56 offen offset:1024
	buffer_load_dwordx4 v[18:21], v55, s[20:23], s56 offen offset:2048
	s_add_u32 s56, s71, 589824
	buffer_load_dwordx4 a[32:35], v9, s[28:31], s56 offen
	s_add_u32 s56, s71, 606208
	buffer_load_dwordx4 a[36:39], v9, s[28:31], s56 offen
	s_add_u32 s56, s71, 655360
	buffer_load_dwordx4 a[40:43], v9, s[28:31], s56 offen
	s_add_u32 s56, s71, 671744
	buffer_load_dwordx4 a[44:47], v9, s[28:31], s56 offen
	s_add_u32 s56, s70, 32768
	buffer_load_dwordx4 a[48:51], v9, s[28:31], s56 offen
	s_add_u32 s56, s70, 49152
	buffer_load_dwordx4 a[52:55], v9, s[28:31], s56 offen
	s_barrier
	s_waitcnt vmcnt(18)
	s_barrier
	s_add_u32 m0, s53, 0
	s_add_u32 s56, s70, 0
	buffer_load_dwordx4 v9, s[28:31], s56 offen lds
	s_add_u32 m0, s53, 2048
	s_add_u32 s56, s70, 16384
	buffer_load_dwordx4 v9, s[28:31], s56 offen lds
	s_add_u32 m0, s53, 4096
	s_add_u32 s56, s70, 98304
	buffer_load_dwordx4 v9, s[28:31], s56 offen lds
	s_add_u32 m0, s53, 6144
	s_add_u32 s56, s70, 114688
	buffer_load_dwordx4 v9, s[28:31], s56 offen lds
	s_add_u32 s56, s70, 131072
	buffer_load_dwordx4 a[56:59], v9, s[28:31], s56 offen
	s_add_u32 s56, s70, 147456
	buffer_load_dwordx4 a[60:63], v9, s[28:31], s56 offen
	s_add_u32 s56, s70, 229376
	buffer_load_dwordx4 a[64:67], v9, s[28:31], s56 offen
	s_add_u32 s56, s70, 245760
	buffer_load_dwordx4 a[68:71], v9, s[28:31], s56 offen
	s_add_u32 s56, s70, 327680
	buffer_load_dwordx4 a[72:75], v9, s[28:31], s56 offen
	s_add_u32 s56, s70, 344064
	buffer_load_dwordx4 a[76:79], v9, s[28:31], s56 offen
	s_waitcnt vmcnt(27)
	ds_write_b128 v52, v[86:89] offset:0
	s_waitcnt vmcnt(26)
	ds_write_b128 v52, v[90:93] offset:1024
	s_waitcnt vmcnt(25)
	ds_write_b128 v52, v[94:97] offset:2048
	s_waitcnt vmcnt(24)
	ds_write_b128 v52, v[98:101] offset:12288
	s_waitcnt vmcnt(23)
	ds_write_b128 v52, v[102:105] offset:13312
	s_waitcnt vmcnt(22)
	ds_write_b128 v52, v[106:109] offset:14336
	s_waitcnt vmcnt(21)
	ds_write_b128 v52, v[110:113] offset:24576
	s_waitcnt vmcnt(20)
	ds_write_b128 v52, v[114:117] offset:25600
	s_waitcnt vmcnt(19)
	ds_write_b128 v52, v[118:121] offset:26624
	s_waitcnt vmcnt(18)
	ds_write_b128 v52, v[10:13] offset:36864
	s_waitcnt vmcnt(17)
	ds_write_b128 v52, v[14:17] offset:37888
	s_waitcnt vmcnt(16)
	ds_write_b128 v52, v[18:21] offset:38912
	ds_read_b64_tr_b16 v[58:59], v56 offset:0
	ds_read_b64_tr_b16 v[60:61], v56 offset:1536
	ds_read_b64_tr_b16 v[62:63], v56 offset:64
	ds_read_b64_tr_b16 v[64:65], v56 offset:1600
	ds_read_b64_tr_b16 v[66:67], v56 offset:128
	ds_read_b64_tr_b16 v[68:69], v56 offset:1664
	ds_read_b64_tr_b16 v[70:71], v56 offset:12288
	ds_read_b64_tr_b16 v[72:73], v56 offset:13824
	ds_read_b64_tr_b16 v[74:75], v56 offset:12352
	ds_read_b64_tr_b16 v[76:77], v56 offset:13888
	ds_read_b64_tr_b16 v[78:79], v56 offset:12416
	ds_read_b64_tr_b16 v[80:81], v56 offset:13952
	s_waitcnt lgkmcnt(11)
	v_dot2c_f32_bf16 v82, s6, v58
	v_dot2c_f32_bf16 v82, s6, v59
	s_waitcnt lgkmcnt(10)
	v_dot2c_f32_bf16 v82, s6, v60
	v_dot2c_f32_bf16 v82, s6, v61
	s_waitcnt lgkmcnt(9)
	v_dot2c_f32_bf16 v83, s6, v62
	v_dot2c_f32_bf16 v83, s6, v63
	s_waitcnt lgkmcnt(8)
	v_dot2c_f32_bf16 v83, s6, v64
	v_dot2c_f32_bf16 v83, s6, v65
	s_waitcnt lgkmcnt(7)
	v_dot2c_f32_bf16 v84, s6, v66
	v_dot2c_f32_bf16 v84, s6, v67
	s_waitcnt lgkmcnt(6)
	v_dot2c_f32_bf16 v84, s6, v68
	v_dot2c_f32_bf16 v84, s6, v69
	ds_read_b64_tr_b16 v[58:59], v56 offset:24576
	ds_read_b64_tr_b16 v[60:61], v56 offset:26112
	ds_read_b64_tr_b16 v[62:63], v56 offset:24640
	ds_read_b64_tr_b16 v[64:65], v56 offset:26176
	ds_read_b64_tr_b16 v[66:67], v56 offset:24704
	ds_read_b64_tr_b16 v[68:69], v56 offset:26240
	s_waitcnt lgkmcnt(11)
	v_dot2c_f32_bf16 v82, s6, v70
	v_dot2c_f32_bf16 v82, s6, v71
	s_waitcnt lgkmcnt(10)
	v_dot2c_f32_bf16 v82, s6, v72
	v_dot2c_f32_bf16 v82, s6, v73
	s_waitcnt lgkmcnt(9)
	v_dot2c_f32_bf16 v83, s6, v74
	v_dot2c_f32_bf16 v83, s6, v75
	s_waitcnt lgkmcnt(8)
	v_dot2c_f32_bf16 v83, s6, v76
	v_dot2c_f32_bf16 v83, s6, v77
	s_waitcnt lgkmcnt(7)
	v_dot2c_f32_bf16 v84, s6, v78
	v_dot2c_f32_bf16 v84, s6, v79
	s_waitcnt lgkmcnt(6)
	v_dot2c_f32_bf16 v84, s6, v80
	v_dot2c_f32_bf16 v84, s6, v81
	ds_read_b64_tr_b16 v[70:71], v56 offset:36864
	ds_read_b64_tr_b16 v[72:73], v56 offset:38400
	ds_read_b64_tr_b16 v[74:75], v56 offset:36928
	ds_read_b64_tr_b16 v[76:77], v56 offset:38464
	ds_read_b64_tr_b16 v[78:79], v56 offset:36992
	ds_read_b64_tr_b16 v[80:81], v56 offset:38528
	s_waitcnt lgkmcnt(11)
	v_dot2c_f32_bf16 v82, s6, v58
	v_dot2c_f32_bf16 v82, s6, v59
	s_waitcnt lgkmcnt(10)
	v_dot2c_f32_bf16 v82, s6, v60
	v_dot2c_f32_bf16 v82, s6, v61
	s_waitcnt lgkmcnt(9)
	v_dot2c_f32_bf16 v83, s6, v62
	v_dot2c_f32_bf16 v83, s6, v63
	s_waitcnt lgkmcnt(8)
	v_dot2c_f32_bf16 v83, s6, v64
	v_dot2c_f32_bf16 v83, s6, v65
	s_waitcnt lgkmcnt(7)
	v_dot2c_f32_bf16 v84, s6, v66
	v_dot2c_f32_bf16 v84, s6, v67
	s_waitcnt lgkmcnt(6)
	v_dot2c_f32_bf16 v84, s6, v68
	v_dot2c_f32_bf16 v84, s6, v69
	ds_read_b64_tr_b16 v[58:59], v57 offset:0
	ds_read_b64_tr_b16 v[60:61], v57 offset:1536
	ds_read_b64_tr_b16 v[62:63], v57 offset:64
	ds_read_b64_tr_b16 v[64:65], v57 offset:1600
	ds_read_b64_tr_b16 v[66:67], v57 offset:128
	ds_read_b64_tr_b16 v[68:69], v57 offset:1664
	s_waitcnt lgkmcnt(11)
	v_dot2c_f32_bf16 v82, s6, v70
	v_dot2c_f32_bf16 v82, s6, v71
	s_waitcnt lgkmcnt(10)
	v_dot2c_f32_bf16 v82, s6, v72
	v_dot2c_f32_bf16 v82, s6, v73
	s_waitcnt lgkmcnt(9)
	v_dot2c_f32_bf16 v83, s6, v74
	v_dot2c_f32_bf16 v83, s6, v75
	s_waitcnt lgkmcnt(8)
	v_dot2c_f32_bf16 v83, s6, v76
	v_dot2c_f32_bf16 v83, s6, v77
	s_waitcnt lgkmcnt(7)
	v_dot2c_f32_bf16 v84, s6, v78
	v_dot2c_f32_bf16 v84, s6, v79
	s_waitcnt lgkmcnt(6)
	v_dot2c_f32_bf16 v84, s6, v80
	v_dot2c_f32_bf16 v84, s6, v81
	ds_read_b64_tr_b16 v[70:71], v57 offset:12288
	ds_read_b64_tr_b16 v[72:73], v57 offset:13824
	ds_read_b64_tr_b16 v[74:75], v57 offset:12352
	ds_read_b64_tr_b16 v[76:77], v57 offset:13888
	ds_read_b64_tr_b16 v[78:79], v57 offset:12416
	ds_read_b64_tr_b16 v[80:81], v57 offset:13952
	s_waitcnt lgkmcnt(11)
	v_dot2c_f32_bf16 v82, s6, v58
	v_dot2c_f32_bf16 v82, s6, v59
	s_waitcnt lgkmcnt(10)
	v_dot2c_f32_bf16 v82, s6, v60
	v_dot2c_f32_bf16 v82, s6, v61
	s_waitcnt lgkmcnt(9)
	v_dot2c_f32_bf16 v83, s6, v62
	v_dot2c_f32_bf16 v83, s6, v63
	s_waitcnt lgkmcnt(8)
	v_dot2c_f32_bf16 v83, s6, v64
	v_dot2c_f32_bf16 v83, s6, v65
	s_waitcnt lgkmcnt(7)
	v_dot2c_f32_bf16 v84, s6, v66
	v_dot2c_f32_bf16 v84, s6, v67
	s_waitcnt lgkmcnt(6)
	v_dot2c_f32_bf16 v84, s6, v68
	v_dot2c_f32_bf16 v84, s6, v69
	ds_read_b64_tr_b16 v[58:59], v57 offset:24576
	ds_read_b64_tr_b16 v[60:61], v57 offset:26112
	ds_read_b64_tr_b16 v[62:63], v57 offset:24640
	ds_read_b64_tr_b16 v[64:65], v57 offset:26176
	ds_read_b64_tr_b16 v[66:67], v57 offset:24704
	ds_read_b64_tr_b16 v[68:69], v57 offset:26240
	s_waitcnt lgkmcnt(11)
	v_dot2c_f32_bf16 v82, s6, v70
	v_dot2c_f32_bf16 v82, s6, v71
	s_waitcnt lgkmcnt(10)
	v_dot2c_f32_bf16 v82, s6, v72
	v_dot2c_f32_bf16 v82, s6, v73
	s_waitcnt lgkmcnt(9)
	v_dot2c_f32_bf16 v83, s6, v74
	v_dot2c_f32_bf16 v83, s6, v75
	s_waitcnt lgkmcnt(8)
	v_dot2c_f32_bf16 v83, s6, v76
	v_dot2c_f32_bf16 v83, s6, v77
	s_waitcnt lgkmcnt(7)
	v_dot2c_f32_bf16 v84, s6, v78
	v_dot2c_f32_bf16 v84, s6, v79
	s_waitcnt lgkmcnt(6)
	v_dot2c_f32_bf16 v84, s6, v80
	v_dot2c_f32_bf16 v84, s6, v81
	ds_read_b64_tr_b16 v[70:71], v57 offset:36864
	ds_read_b64_tr_b16 v[72:73], v57 offset:38400
	ds_read_b64_tr_b16 v[74:75], v57 offset:36928
	ds_read_b64_tr_b16 v[76:77], v57 offset:38464
	ds_read_b64_tr_b16 v[78:79], v57 offset:36992
	ds_read_b64_tr_b16 v[80:81], v57 offset:38528
	s_waitcnt lgkmcnt(11)
	v_dot2c_f32_bf16 v82, s6, v58
	v_dot2c_f32_bf16 v82, s6, v59
	s_waitcnt lgkmcnt(10)
	v_dot2c_f32_bf16 v82, s6, v60
	v_dot2c_f32_bf16 v82, s6, v61
	s_waitcnt lgkmcnt(9)
	v_dot2c_f32_bf16 v83, s6, v62
	v_dot2c_f32_bf16 v83, s6, v63
	s_waitcnt lgkmcnt(8)
	v_dot2c_f32_bf16 v83, s6, v64
	v_dot2c_f32_bf16 v83, s6, v65
	s_waitcnt lgkmcnt(7)
	v_dot2c_f32_bf16 v84, s6, v66
	v_dot2c_f32_bf16 v84, s6, v67
	s_waitcnt lgkmcnt(6)
	v_dot2c_f32_bf16 v84, s6, v68
	v_dot2c_f32_bf16 v84, s6, v69
	s_waitcnt lgkmcnt(5)
	v_dot2c_f32_bf16 v82, s6, v70
	v_dot2c_f32_bf16 v82, s6, v71
	s_waitcnt lgkmcnt(4)
	v_dot2c_f32_bf16 v82, s6, v72
	v_dot2c_f32_bf16 v82, s6, v73
	s_waitcnt lgkmcnt(3)
	v_dot2c_f32_bf16 v83, s6, v74
	v_dot2c_f32_bf16 v83, s6, v75
	s_waitcnt lgkmcnt(2)
	v_dot2c_f32_bf16 v83, s6, v76
	v_dot2c_f32_bf16 v83, s6, v77
	s_waitcnt lgkmcnt(1)
	v_dot2c_f32_bf16 v84, s6, v78
	v_dot2c_f32_bf16 v84, s6, v79
	s_waitcnt lgkmcnt(0)
	v_dot2c_f32_bf16 v84, s6, v80
	v_dot2c_f32_bf16 v84, s6, v81
	s_nop 2
	ds_write_b128 v2, v[82:85] offset:30720
	s_waitcnt vmcnt(6)
	s_waitcnt lgkmcnt(0)
	s_barrier
	s_barrier
	s_add_u32 s56, s70, 425984
	buffer_load_dwordx4 a[80:83], v9, s[28:31], s56 offen
	s_add_u32 s56, s70, 442368
	buffer_load_dwordx4 a[84:87], v9, s[28:31], s56 offen
	s_add_u32 s56, s70, 524288
	buffer_load_dwordx4 a[88:91], v9, s[28:31], s56 offen
	s_add_u32 s56, s70, 540672
	buffer_load_dwordx4 a[92:95], v9, s[28:31], s56 offen
	s_add_u32 s56, s71, 622592
	buffer_load_dwordx4 a[96:99], v9, s[28:31], s56 offen
	s_add_u32 s56, s71, 638976
	buffer_load_dwordx4 a[100:103], v9, s[28:31], s56 offen
	s_add_u32 s56, s71, 688128
	buffer_load_dwordx4 a[104:107], v9, s[28:31], s56 offen
	s_add_u32 s56, s71, 704512
	buffer_load_dwordx4 a[108:111], v9, s[28:31], s56 offen
	s_add_u32 s56, s70, 65536
	buffer_load_dwordx4 a[112:115], v9, s[28:31], s56 offen
	s_add_u32 s56, s70, 81920
	buffer_load_dwordx4 a[116:119], v9, s[28:31], s56 offen
	s_add_u32 s56, s70, 163840
	buffer_load_dwordx4 v[10:13], v9, s[28:31], s56 offen
	s_add_u32 s56, s70, 180224
	buffer_load_dwordx4 v[14:17], v9, s[28:31], s56 offen
	s_add_u32 s56, s70, 262144
	buffer_load_dwordx4 v[18:21], v9, s[28:31], s56 offen
	s_add_u32 s56, s70, 278528
	buffer_load_dwordx4 v[22:25], v9, s[28:31], s56 offen
	s_add_u32 s56, s70, 360448
	buffer_load_dwordx4 v[26:29], v9, s[28:31], s56 offen
	s_add_u32 s56, s70, 376832
	buffer_load_dwordx4 v[30:33], v9, s[28:31], s56 offen
	s_add_u32 s56, s70, 458752
	buffer_load_dwordx4 v[34:37], v9, s[28:31], s56 offen
	s_add_u32 s56, s70, 475136
	buffer_load_dwordx4 v[38:41], v9, s[28:31], s56 offen
	s_add_u32 s56, s70, 557056
	buffer_load_dwordx4 v[42:45], v9, s[28:31], s56 offen
	s_add_u32 s56, s70, 573440
	buffer_load_dwordx4 v[46:49], v9, s[28:31], s56 offen
	ds_write_b128 v2, a[0:3] offset:8192
	ds_write_b128 v2, a[4:7] offset:10240
	ds_write_b128 v2, a[8:11] offset:12288
	ds_write_b128 v2, a[12:15] offset:14336
	ds_write_b128 v2, a[16:19] offset:16384
	ds_write_b128 v2, a[20:23] offset:18432
	ds_write_b128 v2, a[24:27] offset:20480
	ds_write_b128 v2, a[28:31] offset:22528
	ds_write_b128 v2, a[32:35] offset:24576
	ds_write_b128 v2, a[36:39] offset:26624
	ds_write_b128 v2, a[40:43] offset:28672
	s_waitcnt lgkmcnt(0)
	s_barrier
	ds_write_b128 v2, a[44:47] offset:30720
	ds_write_b128 v2, a[48:51] offset:0
	ds_write_b128 v2, a[52:55] offset:2048
	s_waitcnt vmcnt(25)
	ds_write_b128 v2, a[56:59] offset:4096
	s_waitcnt vmcnt(24)
	ds_write_b128 v2, a[60:63] offset:6144
	s_waitcnt vmcnt(23)
	ds_write_b128 v3, a[64:67] offset:0
	s_waitcnt vmcnt(22)
	ds_write_b128 v3, a[68:71] offset:2048
	s_waitcnt vmcnt(21)
	ds_write_b128 v3, a[72:75] offset:4096
	s_waitcnt vmcnt(20)
	ds_write_b128 v3, a[76:79] offset:6144
	s_waitcnt vmcnt(19)
	ds_write_b128 v3, a[80:83] offset:8192
	s_waitcnt vmcnt(18)
	ds_write_b128 v3, a[84:87] offset:10240
	s_waitcnt vmcnt(17)
	ds_write_b128 v3, a[88:91] offset:12288
	s_waitcnt vmcnt(16)
	ds_write_b128 v3, a[92:95] offset:14336
	s_waitcnt vmcnt(15)
	ds_write_b128 v3, a[96:99] offset:16384
	s_waitcnt vmcnt(14)
	ds_write_b128 v3, a[100:103] offset:18432
	s_waitcnt vmcnt(13)
	ds_write_b128 v3, a[104:107] offset:20480
	s_waitcnt vmcnt(12)
	ds_write_b128 v3, a[108:111] offset:22528
	s_waitcnt vmcnt(11)
	ds_write_b128 v3, a[112:115] offset:24576
	s_waitcnt vmcnt(10)
	ds_write_b128 v3, a[116:119] offset:26624
	s_waitcnt vmcnt(9)
	ds_write_b128 v3, v[10:13] offset:28672
	s_waitcnt vmcnt(8)
	ds_write_b128 v3, v[14:17] offset:30720
	s_waitcnt vmcnt(7)
	ds_write_b128 v3, v[18:21] offset:32768
	s_waitcnt vmcnt(6)
	ds_write_b128 v3, v[22:25] offset:34816
	s_waitcnt vmcnt(5)
	ds_write_b128 v3, v[26:29] offset:36864
	s_waitcnt vmcnt(4)
	ds_write_b128 v3, v[30:33] offset:38912
	s_waitcnt vmcnt(3)
	ds_write_b128 v3, v[34:37] offset:40960
	s_waitcnt vmcnt(2)
	ds_write_b128 v3, v[38:41] offset:43008
	s_waitcnt vmcnt(1)
	ds_write_b128 v3, v[42:45] offset:45056
	s_waitcnt vmcnt(0)
	ds_write_b128 v3, v[46:49] offset:47104
	s_waitcnt lgkmcnt(0)
	s_endpgm
CODE_END:
.section .rodata,"a"
.p2align 6
.amdhsa_kernel sequential_preLN__linear_attn_block__dense_activation_gelu__prompt_kernel
  .amdhsa_next_free_vgpr 256
  .amdhsa_next_free_sgpr 102
  .amdhsa_accum_offset 128
  .amdhsa_group_segment_fixed_size 0
  .amdhsa_kernarg_size 88
  .amdhsa_user_sgpr_count 2
  .amdhsa_user_sgpr_kernarg_segment_ptr 1
  .amdhsa_system_sgpr_workgroup_id_x 1
.end_amdhsa_kernel
```
